```python
import torch

def _softmax(x, axis=-1):
    return torch.softmax(x, dim=axis)
def _gelu(x):
    return torch.nn.functional.gelu(x, approximate="tanh")
def _silu(x):
    return torch.nn.functional.silu(x)
def _sigmoid(x):
    return torch.sigmoid(x)
def _layernorm(x, axis=-1, eps=1e-5):
    m = x.mean(dim=axis, keepdim=True)
    v = x.var(dim=axis, keepdim=True, unbiased=False)
    return (x - m) / torch.sqrt(v + eps)
def _scatter_add(tgt, idx, src, axis=0):
    return tgt.clone().index_add_(axis, idx, src)
def _segment_sum(src, seg, n):
    out = torch.zeros((n,) + src.shape[1:], dtype=src.dtype)
    return out.index_add_(0, seg, src)
def _pad(x, pw):
    flat = tuple(v for pair in reversed(pw) for v in pair)
    return torch.nn.functional.pad(x, flat)

kernel_name = 'standalone__gqa_block_cached__near_ridge'

def setup_inputs():

    _w = (lambda a: (lambda t: t.to(torch.bfloat16) if t.is_floating_point() else t)(torch.as_tensor(a)))
    B, Sq, D = 8, 80, 512
    Hq, Hkv, Sk, Dh = 32, 8, 1024, 128
    assert Hq % Hkv == 0, (Hq, Hkv)
    return {
        "x": _w((lambda *s: torch.randn(*s, dtype=torch.bfloat16) * 0.8)(B, Sq, D)),
        "k_cache": _w((lambda *s: torch.randn(*s, dtype=torch.bfloat16) * 0.8)(B, Hkv, Sk, Dh)),
        "v_cache": _w((lambda *s: torch.randn(*s, dtype=torch.bfloat16) * 0.05)(B, Hkv, Sk, Dh)),
        "wq": _w((lambda *s: torch.randn(*s, dtype=torch.bfloat16) * 0.8)(D, Hq * Dh) * (D ** -0.5)),
        "wo": _w((lambda *s: torch.randn(*s, dtype=torch.bfloat16) * 0.05)(Hq * Dh, D) * ((Hq * Dh) ** -0.5)),
    }

def reference(x, k_cache, v_cache, wq, wo):
    B, Sq, D = x.shape
    Hq, Dh = 32, 128
    Hkv = k_cache.shape[1]
    rep = Hq // Hkv
    q = (lambda x, *d: x.permute(*d))((x @ wq).reshape(B, Sq, Hq, Dh), 0, 2, 1, 3)
    k = (lambda x, n, axis: torch.repeat_interleave(x, n, dim=axis))(k_cache, rep, axis=1)
    v = (lambda x, n, axis: torch.repeat_interleave(x, n, dim=axis))(v_cache, rep, axis=1)
    scores = torch.einsum("bhqd,bhkd->bhqk", q, k) * (Dh ** -0.5)
    p = _softmax(scores, axis=-1)
    o = torch.einsum("bhqk,bhkd->bhqd", p, v)
    return (lambda x, *d: x.permute(*d))(o, 0, 2, 1, 3).reshape(B, Sq, Hq * Dh) @ wo
```

```asm
; @launch grid=(256,1,1) block=(256,1,1) lds=163840
.amdgcn_target "amdgcn-amd-amdhsa--gfx950"
.text
.globl standalone__gqa_block_cached__near_ridge_kernel
.p2align 8
.type standalone__gqa_block_cached__near_ridge_kernel,@function
standalone__gqa_block_cached__near_ridge_kernel:
    s_cmp_ge_u32 s2, 256
    s_cbranch_scc1 L_done
    s_load_dwordx16 s[4:19], s[0:1], 0
    s_getpc_b64 s[58:59]
L_pc0:
    s_and_b32 s57, s2, 0xf8
    s_lshl_b32 s57, s57, 5
    v_add_u32 v2, s57, v0
    v_lshlrev_b32 v2, 2, v2
    v_and_b32 v2, 0x7f80, v2
    v_min_u32 v2, L_end-L_pc0-4, v2
    global_load_dword v27, v2, s[58:59]
    v_lshrrev_b32 v1, 6, v0
    v_and_b32 v0, 63, v0
    v_readfirstlane_b32 s3, v1
    s_mov_b32 s23, 1006632960
L_restart:
    s_and_b32 s20, s2, 7
    s_bfe_u32 s21, s2, 196611
    s_lshr_b32 s22, s2, 6
    v_lshlrev_b32 v3, 7, v0
    v_and_b32 v4, 15, v0
    v_lshrrev_b32 v5, 4, v0
    v_bfe_u32 v6, v0, 2, 2
    v_and_b32 v7, 3, v0
    v_xor_b32 v1, v4, v5
    s_lshl_b32 s54, s3, 2
    v_xor_b32 v2, s54, v1
    v_lshlrev_b32 v2, 4, v2
    v_lshl_add_u32 v84, v5, 10, v2
    v_lshlrev_b32 v2, 1, v5
    v_xor_b32 v2, v4, v2
    v_lshlrev_b32 v2, 4, v2
    v_lshl_add_u32 v88, v5, 13, v2
    v_xor_b32 v89, 128, v88
    v_lshl_add_u32 v24, v5, 8, v2
    v_xor_b32 v25, 128, v24
    s_mul_i32 s58, s21, 81920
    s_lshl_b32 s59, s20, 2
    s_add_u32 s59, s59, s22
    s_lshl_b32 s59, s59, 8
    s_sub_u32 s57, 4194304, s59
    s_lshl_b32 s54, s3, 12
    s_mul_i32 s61, s3, 5120
    s_lshl_b32 s95, s3, 10
    s_lshl_b32 s56, s3, 18
    s_lshl_b32 s52, s3, 13
    s_add_u32 s53, s21, s22
    s_add_u32 s62, s53, 0
    s_and_b32 s62, s62, 3
    s_lshl_b32 s60, s62, 8
    s_add_u32 s48, s54, s60
    s_lshl_b32 s60, s62, 20
    s_add_u32 s50, s56, s60
    s_add_u32 s62, s53, 1
    s_and_b32 s62, s62, 3
    s_lshl_b32 s60, s62, 8
    s_add_u32 s49, s54, s60
    s_lshl_b32 s60, s62, 20
    s_add_u32 s51, s56, s60
    s_add_u32 s62, s53, 2
    s_and_b32 s62, s62, 3
    s_lshl_b32 s60, s62, 8
    s_add_u32 s92, s54, s60
    s_lshl_b32 s60, s62, 20
    s_add_u32 s91, s56, s60
    s_add_u32 s62, s53, 3
    s_and_b32 s62, s62, 3
    s_lshl_b32 s60, s62, 8
    s_add_u32 s54, s54, s60
    s_lshl_b32 s60, s62, 20
    s_add_u32 s56, s56, s60
    v_lshlrev_b32 v26, 4, v0
    s_mul_i32 s98, s2, 40960
    s_lshl_b32 s99, s61, 1
    s_add_u32 s98, s98, s99
    s_mov_b32 s101, 9216
    v_mov_b32 v76, -1
    v_mov_b32 v77, -1
    v_mov_b32 v78, -1
    v_mov_b32 v79, -1
    s_waitcnt lgkmcnt(0)
    s_add_u32 s24, s4, s58
    s_addc_u32 s25, s5, 0
    s_mov_b32 s26, 81920
    s_mov_b32 s27, 0x20000
    s_add_u32 s28, s10, s59
    s_addc_u32 s29, s11, 0
    s_mov_b32 s30, s57
    s_mov_b32 s31, 0x20000
    s_add_u32 m0, s95, 0
    s_add_u32 s57, s48, 0
    buffer_load_dwordx4 v84, s[24:27], s57 offen lds
    s_add_u32 m0, s95, 4096
    s_add_u32 s57, s48, 16384
    buffer_load_dwordx4 v84, s[24:27], s57 offen lds
    s_add_u32 m0, s95, 8192
    s_add_u32 s57, s48, 32768
    buffer_load_dwordx4 v84, s[24:27], s57 offen lds
    s_add_u32 m0, s95, 12288
    s_add_u32 s57, s48, 49152
    buffer_load_dwordx4 v84, s[24:27], s57 offen lds
    s_add_u32 s64, s18, s98
    s_addc_u32 s65, s19, 0
    s_mov_b32 s66, 10240
    s_mov_b32 s67, 0x20000
    s_lshl_b32 s98, s21, 3
    s_add_u32 s98, s98, s20
    s_lshl_b32 s98, s98, 18
    s_lshl_b32 s99, s3, 16
    s_add_u32 s98, s98, s99
    s_add_u32 s32, s6, s98
    s_addc_u32 s33, s7, 0
    s_mov_b32 s34, 65536
    s_mov_b32 s35, 0x20000
    s_add_u32 s36, s8, s98
    s_addc_u32 s37, s9, 0
    s_mov_b32 s38, 65536
    s_mov_b32 s39, 0x20000
    s_bitcmp1_b32 s21, 0
    s_mov_b32 s94, 19088743
    s_cselect_b32 s94, 19088743, s94
    s_mov_b32 s93, 5472256
    s_cselect_b32 s93, 5472256, s93
    s_mov_b32 s90, 43819008
    s_cselect_b32 s90, 43819008, s90
    s_add_u32 m0, s95, 16384
    s_add_u32 s57, s48, 65536
    buffer_load_dwordx4 v84, s[24:27], s57 offen lds
    s_bitcmp1_b32 s22, 0
    s_cselect_b32 s94, s94, 1985229328
    s_cselect_b32 s93, s93, 262955008
    s_cselect_b32 s90, s90, 2103656448
    v_lshlrev_b32 v72, 4, v1
    v_lshl_add_u32 v90, v4, 8, v72
    v_xor_b32 v91, 64, v90
    v_xor_b32 v92, 128, v90
    v_xor_b32 v93, 192, v90
    v_lshl_add_u32 v20, v5, 8, v72
    v_xor_b32 v21, 64, v20
    v_xor_b32 v22, 128, v20
    v_xor_b32 v23, 192, v20
    v_lshrrev_b32 v68, 2, v4
    v_lshlrev_b32 v68, 3, v68
    v_and_b32 v71, 3, v4
    v_add_u32 v68, v68, v71
    v_lshl_add_u32 v72, v68, 8, v72
    v_add_u32 v72, s52, v72
    v_add_u32 v8, 53248, v72
    s_add_u32 m0, s52, 20480
    s_add_u32 s57, s50, 0
    buffer_load_dwordx4 v88, s[28:31], s57 offen lds
    v_xor_b32 v9, 64, v8
    v_xor_b32 v10, 128, v8
    v_xor_b32 v11, 192, v8
    v_lshl_add_u32 v72, v5, 3, v6
    v_lshlrev_b32 v72, 8, v72
    v_lshl_add_u32 v72, v7, 3, v72
    v_and_b32 v68, 1, v5
    v_lshl_add_u32 v68, v68, 2, v6
    s_lshl_b32 s98, s3, 1
    s_add_u32 s99, s98, 0
    s_and_b32 s99, s99, 7
    v_xor_b32 v71, s99, v68
    v_lshl_add_u32 v71, v71, 5, v72
    v_add_u32 v94, 20480, v71
    v_add_u32 v12, s52, v71
    s_add_u32 s99, s98, 1
    s_and_b32 s99, s99, 7
    v_xor_b32 v71, s99, v68
    v_lshl_add_u32 v71, v71, 5, v72
    v_add_u32 v95, 20480, v71
    s_add_u32 m0, s52, 21504
    s_add_u32 s57, s50, 32768
    buffer_load_dwordx4 v88, s[28:31], s57 offen lds
    v_add_u32 v13, s52, v71
    s_add_u32 s99, s98, 2
    s_and_b32 s99, s99, 7
    v_xor_b32 v71, s99, v68
    v_lshl_add_u32 v71, v71, 5, v72
    v_add_u32 v14, s52, v71
    s_add_u32 s99, s98, 3
    s_and_b32 s99, s99, 7
    v_xor_b32 v71, s99, v68
    v_lshl_add_u32 v71, v71, 5, v72
    v_add_u32 v15, s52, v71
    s_add_u32 s99, s98, 4
    s_and_b32 s99, s99, 7
    v_xor_b32 v71, s99, v68
    v_lshl_add_u32 v71, v71, 5, v72
    v_add_u32 v16, s52, v71
    s_add_u32 s99, s98, 5
    s_and_b32 s99, s99, 7
    v_xor_b32 v71, s99, v68
    v_lshl_add_u32 v71, v71, 5, v72
    s_add_u32 m0, s52, 22528
    s_add_u32 s57, s50, 65536
    buffer_load_dwordx4 v89, s[28:31], s57 offen lds
    v_add_u32 v17, s52, v71
    s_add_u32 s99, s98, 6
    s_and_b32 s99, s99, 7
    v_xor_b32 v71, s99, v68
    v_lshl_add_u32 v71, v71, 5, v72
    v_add_u32 v18, s52, v71
    s_add_u32 s99, s98, 7
    s_and_b32 s99, s99, 7
    v_xor_b32 v71, s99, v68
    v_lshl_add_u32 v71, v71, 5, v72
    v_add_u32 v19, s52, v71
    v_mov_b32 v96, 0
    v_mov_b32 v97, 0
    v_mov_b32 v98, 0
    v_mov_b32 v99, 0
    v_mov_b32 v100, 0
    v_mov_b32 v101, 0
    v_mov_b32 v102, 0
    v_mov_b32 v103, 0
    v_mov_b32 v104, 0
    s_add_u32 m0, s52, 23552
    s_add_u32 s57, s50, 98304
    buffer_load_dwordx4 v89, s[28:31], s57 offen lds
    v_mov_b32 v105, 0
    v_mov_b32 v106, 0
    v_mov_b32 v107, 0
    v_mov_b32 v108, 0
    v_mov_b32 v109, 0
    v_mov_b32 v110, 0
    v_mov_b32 v111, 0
    v_mov_b32 v112, 0
    v_mov_b32 v113, 0
    v_mov_b32 v114, 0
    v_mov_b32 v115, 0
    v_mov_b32 v116, 0
    v_mov_b32 v117, 0
    v_mov_b32 v118, 0
    v_mov_b32 v119, 0
    v_mov_b32 v120, 0
    v_mov_b32 v121, 0
    v_mov_b32 v122, 0
    v_mov_b32 v123, 0
    v_mov_b32 v124, 0
    s_add_u32 m0, s52, 24576
    s_add_u32 s57, s50, 131072
    buffer_load_dwordx4 v88, s[28:31], s57 offen lds
    v_mov_b32 v125, 0
    v_mov_b32 v126, 0
    v_mov_b32 v127, 0
    v_mov_b32 v128, 0
    v_mov_b32 v129, 0
    v_mov_b32 v130, 0
    v_mov_b32 v131, 0
    v_mov_b32 v132, 0
    v_mov_b32 v133, 0
    v_mov_b32 v134, 0
    v_mov_b32 v135, 0
    v_mov_b32 v136, 0
    v_mov_b32 v137, 0
    v_mov_b32 v138, 0
    v_mov_b32 v139, 0
    v_mov_b32 v140, 0
    v_mov_b32 v141, 0
    v_mov_b32 v142, 0
    v_mov_b32 v143, 0
    v_mov_b32 v144, 0
    s_add_u32 m0, s52, 25600
    s_add_u32 s57, s50, 163840
    buffer_load_dwordx4 v88, s[28:31], s57 offen lds
    v_mov_b32 v145, 0
    v_mov_b32 v146, 0
    v_mov_b32 v147, 0
    v_mov_b32 v148, 0
    v_mov_b32 v149, 0
    v_mov_b32 v150, 0
    v_mov_b32 v151, 0
    v_mov_b32 v152, 0
    v_mov_b32 v153, 0
    v_mov_b32 v154, 0
    v_mov_b32 v155, 0
    v_mov_b32 v156, 0
    v_mov_b32 v157, 0
    v_mov_b32 v158, 0
    v_mov_b32 v159, 0
    v_mov_b32 v160, 0
    v_mov_b32 v161, 0
    v_mov_b32 v162, 0
    v_mov_b32 v163, 0
    v_mov_b32 v164, 0
    s_add_u32 m0, s52, 26624
    s_add_u32 s57, s50, 196608
    buffer_load_dwordx4 v89, s[28:31], s57 offen lds
    v_mov_b32 v165, 0
    v_mov_b32 v166, 0
    v_mov_b32 v167, 0
    v_mov_b32 v168, 0
    v_mov_b32 v169, 0
    v_mov_b32 v170, 0
    v_mov_b32 v171, 0
    v_mov_b32 v172, 0
    v_mov_b32 v173, 0
    v_mov_b32 v174, 0
    v_mov_b32 v175, 0
    v_mov_b32 v176, 0
    v_mov_b32 v177, 0
    v_mov_b32 v178, 0
    v_mov_b32 v179, 0
    v_mov_b32 v180, 0
    v_mov_b32 v181, 0
    v_mov_b32 v182, 0
    v_mov_b32 v183, 0
    v_mov_b32 v184, 0
    s_add_u32 m0, s52, 27648
    s_add_u32 s57, s50, 229376
    buffer_load_dwordx4 v89, s[28:31], s57 offen lds
    v_mov_b32 v185, 0
    v_mov_b32 v186, 0
    v_mov_b32 v187, 0
    v_mov_b32 v188, 0
    v_mov_b32 v189, 0
    v_mov_b32 v190, 0
    v_mov_b32 v191, 0
    v_mov_b32 v192, 0
    v_mov_b32 v193, 0
    v_mov_b32 v194, 0
    v_mov_b32 v195, 0
    v_mov_b32 v196, 0
    v_mov_b32 v197, 0
    v_mov_b32 v198, 0
    v_mov_b32 v199, 0
    v_mov_b32 v200, 0
    v_mov_b32 v201, 0
    v_mov_b32 v202, 0
    v_mov_b32 v203, 0
    v_mov_b32 v204, 0
    s_add_u32 m0, s95, 53248
    s_add_u32 s57, s49, 0
    buffer_load_dwordx4 v84, s[24:27], s57 offen lds
    v_mov_b32 v205, 0
    v_mov_b32 v206, 0
    v_mov_b32 v207, 0
    v_mov_b32 v208, 0
    v_mov_b32 v209, 0
    v_mov_b32 v210, 0
    v_mov_b32 v211, 0
    v_mov_b32 v212, 0
    v_mov_b32 v213, 0
    v_mov_b32 v214, 0
    v_mov_b32 v215, 0
    v_mov_b32 v216, 0
    v_mov_b32 v217, 0
    v_mov_b32 v218, 0
    v_mov_b32 v219, 0
    v_mov_b32 v220, 0
    v_mov_b32 v221, 0
    v_mov_b32 v222, 0
    v_mov_b32 v223, 0
    v_mov_b32 v224, 0
    s_add_u32 m0, s95, 57344
    s_add_u32 s57, s49, 16384
    buffer_load_dwordx4 v84, s[24:27], s57 offen lds
    v_mov_b32 v225, 0
    v_mov_b32 v226, 0
    v_mov_b32 v227, 0
    v_mov_b32 v228, 0
    v_mov_b32 v229, 0
    v_mov_b32 v230, 0
    v_mov_b32 v231, 0
    v_mov_b32 v232, 0
    v_mov_b32 v233, 0
    v_mov_b32 v234, 0
    v_mov_b32 v235, 0
    v_mov_b32 v236, 0
    v_mov_b32 v237, 0
    v_mov_b32 v238, 0
    v_mov_b32 v239, 0
    v_mov_b32 v240, 0
    v_mov_b32 v241, 0
    v_mov_b32 v242, 0
    v_mov_b32 v243, 0
    v_mov_b32 v244, 0
    s_add_u32 m0, s95, 61440
    s_add_u32 s57, s49, 32768
    buffer_load_dwordx4 v84, s[24:27], s57 offen lds
    v_mov_b32 v245, 0
    v_mov_b32 v246, 0
    v_mov_b32 v247, 0
    v_mov_b32 v248, 0
    v_mov_b32 v249, 0
    v_mov_b32 v250, 0
    v_mov_b32 v251, 0
    v_mov_b32 v252, 0
    v_mov_b32 v253, 0
    v_mov_b32 v254, 0
    v_mov_b32 v255, 0
    s_and_b32 s98, s2, 63
    s_mul_i32 s98, s98, 40960
    s_add_u32 s40, s18, s98
    s_addc_u32 s41, s19, 0
    s_mov_b32 s42, 7905280
    s_mov_b32 s43, 0x20000
    s_mul_i32 s60, s22, 2621440
    s_lshl_b32 s100, s61, 1
    s_add_u32 s60, s60, s100
    s_lshl_b32 s63, s2, 2
    s_add_u32 s63, s63, s3
    s_lshl_b32 s63, s63, 6
    s_add_u32 s63, s63, 16777216
    s_and_b32 s98, s2, 63
    s_lshl_b32 s98, s98, 2
    s_add_u32 s98, s98, s3
    s_lshl_b32 s98, s98, 6
    s_add_u32 s98, s98, 16777216
    v_and_b32 v68, 3, v0
    v_lshl_add_u32 v68, v68, 14, s98
    s_and_b32 s98, s2, 0xf8
    s_lshl_b32 s98, s98, 8
    s_lshr_b32 s99, s20, 1
    s_lshl_b32 s99, s99, 6
    v_cmp_gt_u32 vcc, 16, v0
    s_add_u32 s98, s98, s99
    s_add_u32 s98, s98, 16777220
    v_and_b32 v69, 7, v0
    v_lshl_add_u32 v69, v69, 8, s98
    v_cndmask_b32 v68, v69, v68, vcc
    v_accvgpr_write_b32 a234, v68
    s_lshl_b32 s98, s20, 19
    s_lshl_b32 s99, s22, 8
    s_add_u32 s98, s98, s99
    s_sub_u32 s99, 524288, s99
    s_add_u32 s44, s12, s98
    s_addc_u32 s45, s13, 0
    s_mov_b32 s46, s99
    s_mov_b32 s47, 0x20000
    v_lshlrev_b32 v71, 2, v5
    v_sub_u32 v71, v4, v71
    v_and_b32 v72, 1, v71
    v_lshlrev_b32 v72, 4, v72
    v_mov_b32 v68, 0x3f80
    v_lshlrev_b32 v72, v72, v68
    v_lshrrev_b32 v71, 1, v71
    v_cmp_eq_u32 vcc, 0, v71
    v_accvgpr_write_b32 a228, 0
    v_accvgpr_write_b32 a229, 0
    v_cndmask_b32 v68, 0, v72, vcc
    v_cmp_eq_u32 vcc, 1, v71
    v_accvgpr_write_b32 a232, 0
    v_accvgpr_write_b32 a233, 0
    v_cndmask_b32 v69, 0, v72, vcc
    v_accvgpr_write_b32 a230, v68
    v_accvgpr_write_b32 a231, v69
    s_add_u32 s99, s3, 1
    s_and_b32 s99, s99, 3
    s_mul_i32 s98, s99, 3072
    v_add_u32 v71, s98, v26
    v_accvgpr_write_b32 a235, v71
    s_add_u32 s99, s3, 2
    s_and_b32 s99, s99, 3
    s_mul_i32 s98, s99, 3072
    s_add_u32 s98, s98, 1024
    v_add_u32 v71, s98, v26
    v_accvgpr_write_b32 a236, v71
    s_add_u32 s99, s3, 3
    s_and_b32 s99, s99, 3
    s_mul_i32 s98, s99, 3072
    s_add_u32 s98, s98, 2048
    v_add_u32 v71, s98, v26
    v_accvgpr_write_b32 a237, v71
    s_add_u32 s99, s3, 0
    s_and_b32 s99, s99, 3
    s_mul_i32 s98, s99, 3072
    v_add_u32 v71, s98, v26
    v_accvgpr_write_b32 a238, v71
    s_lshl_b32 s98, s3, 2
    s_add_u32 s98, s98, 151552
    v_lshl_add_u32 v71, v4, 4, s98
    v_mul_u32_u24 v72, 1288, v5
    v_add_u32 v71, v71, v72
    v_accvgpr_write_b32 a239, v71
    v_lshlrev_b32 v71, 4, v4
    v_add_u32 v71, 151552, v71
    v_accvgpr_write_b32 a240, v71
    v_and_b32 v71, 1, v5
    v_lshlrev_b32 v71, 1, v71
    v_xor_b32 v71, v4, v71
    v_lshlrev_b32 v71, 4, v71
    v_lshl_add_u32 v71, v5, 12, v71
    v_xor_b32 v72, 0, v71
    v_accvgpr_write_b32 a241, v72
    v_xor_b32 v72, 64, v71
    v_accvgpr_write_b32 a242, v72
    v_xor_b32 v72, 128, v71
    v_accvgpr_write_b32 a243, v72
    v_xor_b32 v72, 192, v71
    v_accvgpr_write_b32 a244, v72
    v_lshl_add_u32 v72, v6, 2, v5
    v_lshlrev_b32 v72, 8, v72
    v_lshl_add_u32 v72, v7, 3, v72
    v_and_b32 v68, 1, v5
    v_lshl_add_u32 v68, v6, 1, v68
    s_lshl_b32 s98, s3, 1
    s_add_u32 s99, s98, 0
    v_xor_b32 v71, s99, v68
    v_lshl_add_u32 v71, v71, 5, v72
    v_add_u32 v71, 53248, v71
    v_accvgpr_write_b32 a245, v71
    s_add_u32 s99, s98, 1
    v_xor_b32 v71, s99, v68
    v_lshl_add_u32 v71, v71, 5, v72
    v_add_u32 v71, 53248, v71
    v_accvgpr_write_b32 a246, v71
    s_add_u32 s98, s22, 0
    s_and_b32 s98, s98, 3
    s_mul_i32 s99, s98, 2621440
    s_add_u32 s8, s99, s100
    s_lshl_b32 s98, s98, 2
    s_add_u32 s98, s98, s3
    s_lshl_b32 s4, s98, 15
    s_add_u32 s98, s22, 1
    s_and_b32 s98, s98, 3
    s_mul_i32 s99, s98, 2621440
    s_add_u32 s9, s99, s100
    s_lshl_b32 s98, s98, 2
    s_add_u32 s98, s98, s3
    s_lshl_b32 s5, s98, 15
    s_add_u32 s98, s22, 2
    s_and_b32 s98, s98, 3
    s_mul_i32 s99, s98, 2621440
    s_add_u32 s10, s99, s100
    s_lshl_b32 s98, s98, 2
    s_add_u32 s98, s98, s3
    s_lshl_b32 s6, s98, 15
    s_add_u32 s98, s22, 3
    s_and_b32 s98, s98, 3
    s_mul_i32 s99, s98, 2621440
    s_add_u32 s11, s99, s100
    s_lshl_b32 s98, s98, 2
    s_add_u32 s98, s98, s3
    s_lshl_b32 s7, s98, 15
    v_accvgpr_write_b32 a208, 0
    v_accvgpr_write_b32 a209, 0
    v_accvgpr_write_b32 a210, 0
    v_accvgpr_write_b32 a211, 0
    v_accvgpr_write_b32 a212, 0
    v_accvgpr_write_b32 a213, 0
    v_accvgpr_write_b32 a214, 0
    v_accvgpr_write_b32 a215, 0
    v_accvgpr_write_b32 a216, 0
    v_accvgpr_write_b32 a217, 0
    v_accvgpr_write_b32 a218, 0
    v_accvgpr_write_b32 a219, 0
    v_accvgpr_write_b32 a220, 0
    v_accvgpr_write_b32 a221, 0
    v_accvgpr_write_b32 a222, 0
    v_accvgpr_write_b32 a223, 0
    v_accvgpr_write_b32 a224, 0
    v_accvgpr_write_b32 a225, 0
    v_accvgpr_write_b32 a226, 0
    v_accvgpr_write_b32 a227, 0
    v_mov_b32 v71, 0x3f803f80
    v_accvgpr_write_b32 a248, v71
    v_accvgpr_write_b32 a249, v71
    v_accvgpr_write_b32 a250, v71
    v_accvgpr_write_b32 a251, v71
    s_mov_b32 s96, 1040356334
    s_lshl_b32 s98, s3, 2
    v_lshrrev_b32 v73, 1, v5
    v_add_u32 v73, s98, v73
    v_xor_b32 v73, v73, v4
    v_lshlrev_b32 v73, 4, v73
    v_lshl_add_u32 v73, v4, 8, v73
    v_and_b32 v74, 1, v5
    v_lshl_add_u32 v73, v74, 3, v73
    v_add_u32 v73, 32768, v73
    v_xor_b32 v74, 32, v73
    s_waitcnt vmcnt(3)
    s_barrier
    ds_read_b64_tr_b16 a[184:185], v94 offset:0
    ds_read_b64_tr_b16 a[186:187], v94 offset:1024
    ds_read_b64_tr_b16 a[188:189], v95 offset:0
    ds_read_b64_tr_b16 a[190:191], v95 offset:1024
    ds_read_b128 a[144:147], v90 offset:0
    ds_read_b128 a[148:151], v90 offset:4096
    ds_read_b128 a[152:155], v90 offset:8192
    ds_read_b128 a[156:159], v90 offset:12288
    ds_read_b128 a[160:163], v90 offset:16384
    s_waitcnt lgkmcnt(3)
    v_mfma_f32_16x16x32_bf16 v[28:31], a[184:187], a[144:147], 0
    ds_read_b64_tr_b16 a[192:193], v94 offset:8192
    ds_read_b64_tr_b16 a[194:195], v94 offset:9216
    ds_read_b64_tr_b16 a[196:197], v95 offset:8192
    v_mfma_f32_16x16x32_bf16 v[32:35], a[188:191], a[144:147], 0
    ds_read_b64_tr_b16 a[198:199], v95 offset:9216
    ds_read_b128 a[164:167], v91 offset:0
    ds_read_b128 a[168:171], v91 offset:4096
    v_mfma_f32_16x16x32_bf16 v[36:39], a[184:187], a[148:151], 0
    ds_read_b128 a[172:175], v91 offset:8192
    ds_read_b128 a[176:179], v91 offset:12288
    ds_read_b128 a[180:183], v91 offset:16384
    v_mfma_f32_16x16x32_bf16 v[40:43], a[188:191], a[148:151], 0
    s_waitcnt lgkmcnt(9)
    s_add_u32 m0, s95, 65536
    s_add_u32 s57, s49, 49152
    buffer_load_dwordx4 v84, s[24:27], s57 offen lds
    v_mfma_f32_16x16x32_bf16 v[44:47], a[184:187], a[152:155], 0
    s_add_u32 m0, s95, 69632
    s_add_u32 s57, s49, 65536
    buffer_load_dwordx4 v84, s[24:27], s57 offen lds
    v_mfma_f32_16x16x32_bf16 v[48:51], a[188:191], a[152:155], 0
    s_add_u32 m0, s52, 73728
    s_add_u32 s57, s51, 0
    buffer_load_dwordx4 v88, s[28:31], s57 offen lds
    v_mfma_f32_16x16x32_bf16 v[52:55], a[184:187], a[156:159], 0
    s_add_u32 m0, s52, 74752
    s_add_u32 s57, s51, 32768
    buffer_load_dwordx4 v88, s[28:31], s57 offen lds
    v_mfma_f32_16x16x32_bf16 v[56:59], a[188:191], a[156:159], 0
    s_add_u32 m0, s52, 75776
    s_add_u32 s57, s51, 65536
    buffer_load_dwordx4 v89, s[28:31], s57 offen lds
    v_mfma_f32_16x16x32_bf16 v[60:63], a[184:187], a[160:163], 0
    s_add_u32 m0, s52, 76800
    s_add_u32 s57, s51, 98304
    buffer_load_dwordx4 v89, s[28:31], s57 offen lds
    v_mfma_f32_16x16x32_bf16 v[64:67], a[188:191], a[160:163], 0
    s_waitcnt lgkmcnt(3)
    s_add_u32 m0, s52, 77824
    s_add_u32 s57, s51, 131072
    buffer_load_dwordx4 v88, s[28:31], s57 offen lds
    v_mfma_f32_16x16x32_bf16 v[28:31], a[192:195], a[164:167], v[28:31]
    ds_read_b64_tr_b16 a[184:185], v94 offset:16384
    ds_read_b64_tr_b16 a[186:187], v94 offset:17408
    ds_read_b64_tr_b16 a[188:189], v95 offset:16384
    v_mfma_f32_16x16x32_bf16 v[32:35], a[196:199], a[164:167], v[32:35]
    ds_read_b64_tr_b16 a[190:191], v95 offset:17408
    ds_read_b128 a[144:147], v92 offset:0
    ds_read_b128 a[148:151], v92 offset:4096
    v_mfma_f32_16x16x32_bf16 v[36:39], a[192:195], a[168:171], v[36:39]
    ds_read_b128 a[152:155], v92 offset:8192
    ds_read_b128 a[156:159], v92 offset:12288
    ds_read_b128 a[160:163], v92 offset:16384
    v_mfma_f32_16x16x32_bf16 v[40:43], a[196:199], a[168:171], v[40:43]
    s_waitcnt lgkmcnt(9)
    s_add_u32 m0, s52, 78848
    s_add_u32 s57, s51, 163840
    buffer_load_dwordx4 v88, s[28:31], s57 offen lds
    v_mfma_f32_16x16x32_bf16 v[44:47], a[192:195], a[172:175], v[44:47]
    s_add_u32 m0, s52, 79872
    s_add_u32 s57, s51, 196608
    buffer_load_dwordx4 v89, s[28:31], s57 offen lds
    v_mfma_f32_16x16x32_bf16 v[48:51], a[196:199], a[172:175], v[48:51]
    s_add_u32 m0, s52, 80896
    s_add_u32 s57, s51, 229376
    buffer_load_dwordx4 v89, s[28:31], s57 offen lds
    v_mfma_f32_16x16x32_bf16 v[52:55], a[192:195], a[176:179], v[52:55]
    s_bfe_u32 s58, s21, 65536
    s_lshr_b32 s59, s22, 1
    s_cmp_eq_u32 s58, s59
    s_cselect_b32 s58, 0, 0x10000
    s_cselect_b64 exec, -1, 1
    s_bfe_u32 s59, s94, 262144
    s_lshl_b32 s59, s59, 13
    s_or_b32 s59, s59, s58
    buffer_load_dword v27, v3, s[32:35], s59 offen
    s_mov_b32 exec_hi, 0
    s_bfe_u32 s59, s94, 262144
    s_lshl_b32 s59, s59, 13
    s_or_b32 s59, s59, s58
    s_or_b32 s59, s59, 4096
    buffer_load_dword v27, v3, s[36:39], s59 offen
    s_mov_b64 exec, -1
    v_mfma_f32_16x16x32_bf16 v[56:59], a[196:199], a[176:179], v[56:59]
    s_add_u32 m0, s95, 106496
    s_add_u32 s57, s92, 0
    buffer_load_dwordx4 v84, s[24:27], s57 offen lds
    v_mfma_f32_16x16x32_bf16 v[60:63], a[192:195], a[180:183], v[60:63]
    s_add_u32 m0, s95, 110592
    s_add_u32 s57, s92, 16384
    buffer_load_dwordx4 v84, s[24:27], s57 offen lds
    v_mfma_f32_16x16x32_bf16 v[64:67], a[196:199], a[180:183], v[64:67]
    s_waitcnt lgkmcnt(3)
    s_add_u32 m0, s95, 114688
    s_add_u32 s57, s92, 32768
    buffer_load_dwordx4 v84, s[24:27], s57 offen lds
    v_mfma_f32_16x16x32_bf16 v[28:31], a[184:187], a[144:147], v[28:31]
    ds_read_b64_tr_b16 a[192:193], v94 offset:24576
    ds_read_b64_tr_b16 a[194:195], v94 offset:25600
    ds_read_b64_tr_b16 a[196:197], v95 offset:24576
    v_mfma_f32_16x16x32_bf16 v[32:35], a[188:191], a[144:147], v[32:35]
    ds_read_b64_tr_b16 a[198:199], v95 offset:25600
    ds_read_b128 a[164:167], v93 offset:0
    ds_read_b128 a[168:171], v93 offset:4096
    v_mfma_f32_16x16x32_bf16 v[36:39], a[184:187], a[148:151], v[36:39]
    ds_read_b128 a[172:175], v93 offset:8192
    ds_read_b128 a[176:179], v93 offset:12288
    ds_read_b128 a[180:183], v93 offset:16384
    v_mfma_f32_16x16x32_bf16 v[40:43], a[188:191], a[148:151], v[40:43]
    s_waitcnt lgkmcnt(9)
    s_add_u32 m0, s95, 118784
    s_add_u32 s57, s92, 49152
    buffer_load_dwordx4 v84, s[24:27], s57 offen lds
    v_mfma_f32_16x16x32_bf16 v[44:47], a[184:187], a[152:155], v[44:47]
    s_add_u32 m0, s95, 122880
    s_add_u32 s57, s92, 65536
    buffer_load_dwordx4 v84, s[24:27], s57 offen lds
    v_mfma_f32_16x16x32_bf16 v[48:51], a[188:191], a[152:155], v[48:51]
    s_add_u32 m0, s52, 126976
    s_add_u32 s57, s91, 0
    buffer_load_dwordx4 v88, s[28:31], s57 offen lds
    v_mfma_f32_16x16x32_bf16 v[52:55], a[184:187], a[156:159], v[52:55]
    s_add_u32 m0, s52, 128000
    s_add_u32 s57, s91, 32768
    buffer_load_dwordx4 v88, s[28:31], s57 offen lds
    v_mfma_f32_16x16x32_bf16 v[56:59], a[188:191], a[156:159], v[56:59]
    s_add_u32 m0, s52, 129024
    s_add_u32 s57, s91, 65536
    buffer_load_dwordx4 v89, s[28:31], s57 offen lds
    v_mfma_f32_16x16x32_bf16 v[60:63], a[184:187], a[160:163], v[60:63]
    v_mfma_f32_16x16x32_bf16 v[64:67], a[188:191], a[160:163], v[64:67]
    s_waitcnt lgkmcnt(3)
    v_mfma_f32_16x16x32_bf16 v[28:31], a[192:195], a[164:167], v[28:31]
    v_add_u32 v90, 53248, v90
    v_add_u32 v91, 53248, v91
    v_mfma_f32_16x16x32_bf16 v[32:35], a[196:199], a[164:167], v[32:35]
    v_add_u32 v92, 53248, v92
    v_add_u32 v93, 53248, v93
    v_mfma_f32_16x16x32_bf16 v[36:39], a[192:195], a[168:171], v[36:39]
    v_add_u32 v94, 53248, v94
    v_add_u32 v95, 53248, v95
    v_mfma_f32_16x16x32_bf16 v[40:43], a[196:199], a[168:171], v[40:43]
    s_waitcnt vmcnt(10) lgkmcnt(0)
    s_barrier
    v_mfma_f32_16x16x32_bf16 v[44:47], a[192:195], a[172:175], v[44:47]
    ds_read_b64_tr_b16 a[184:185], v94 offset:0
    ds_read_b64_tr_b16 a[186:187], v94 offset:1024
    ds_read_b64_tr_b16 a[188:189], v95 offset:0
    v_mfma_f32_16x16x32_bf16 v[48:51], a[196:199], a[172:175], v[48:51]
    ds_read_b64_tr_b16 a[190:191], v95 offset:1024
    ds_read_b128 a[144:147], v90 offset:0
    ds_read_b128 a[148:151], v90 offset:4096
    v_mfma_f32_16x16x32_bf16 v[52:55], a[192:195], a[176:179], v[52:55]
    ds_read_b128 a[152:155], v90 offset:8192
    ds_read_b128 a[156:159], v90 offset:12288
    ds_read_b128 a[160:163], v90 offset:16384
    v_mfma_f32_16x16x32_bf16 v[56:59], a[196:199], a[176:179], v[56:59]
    s_add_u32 m0, s52, 130048
    s_add_u32 s57, s91, 98304
    buffer_load_dwordx4 v89, s[28:31], s57 offen lds
    v_mfma_f32_16x16x32_bf16 v[60:63], a[192:195], a[180:183], v[60:63]
    s_add_u32 m0, s52, 131072
    s_add_u32 s57, s91, 131072
    buffer_load_dwordx4 v88, s[28:31], s57 offen lds
    v_mfma_f32_16x16x32_bf16 v[64:67], a[196:199], a[180:183], v[64:67]
    s_waitcnt lgkmcnt(3)
    s_add_u32 m0, s52, 132096
    s_add_u32 s57, s91, 163840
    buffer_load_dwordx4 v88, s[28:31], s57 offen lds
    v_mfma_f32_16x16x32_bf16 v[28:31], a[184:187], a[144:147], v[28:31]
    ds_read_b64_tr_b16 a[192:193], v94 offset:8192
    ds_read_b64_tr_b16 a[194:195], v94 offset:9216
    ds_read_b64_tr_b16 a[196:197], v95 offset:8192
    v_mfma_f32_16x16x32_bf16 v[32:35], a[188:191], a[144:147], v[32:35]
    ds_read_b64_tr_b16 a[198:199], v95 offset:9216
    ds_read_b128 a[164:167], v91 offset:0
    ds_read_b128 a[168:171], v91 offset:4096
    v_mfma_f32_16x16x32_bf16 v[36:39], a[184:187], a[148:151], v[36:39]
    ds_read_b128 a[172:175], v91 offset:8192
    ds_read_b128 a[176:179], v91 offset:12288
    ds_read_b128 a[180:183], v91 offset:16384
    v_mfma_f32_16x16x32_bf16 v[40:43], a[188:191], a[148:151], v[40:43]
    s_waitcnt lgkmcnt(9)
    s_add_u32 m0, s52, 133120
    s_add_u32 s57, s91, 196608
    buffer_load_dwordx4 v89, s[28:31], s57 offen lds
    v_mfma_f32_16x16x32_bf16 v[44:47], a[184:187], a[152:155], v[44:47]
    s_add_u32 m0, s52, 134144
    s_add_u32 s57, s91, 229376
    buffer_load_dwordx4 v89, s[28:31], s57 offen lds
    v_mfma_f32_16x16x32_bf16 v[48:51], a[188:191], a[152:155], v[48:51]
    s_add_u32 m0, s95, 0
    s_add_u32 s57, s54, 0
    buffer_load_dwordx4 v84, s[24:27], s57 offen lds
    v_mfma_f32_16x16x32_bf16 v[52:55], a[184:187], a[156:159], v[52:55]
    s_add_u32 m0, s95, 4096
    s_add_u32 s57, s54, 16384
    buffer_load_dwordx4 v84, s[24:27], s57 offen lds
    v_mfma_f32_16x16x32_bf16 v[56:59], a[188:191], a[156:159], v[56:59]
    s_add_u32 m0, s95, 8192
    s_add_u32 s57, s54, 32768
    buffer_load_dwordx4 v84, s[24:27], s57 offen lds
    v_mfma_f32_16x16x32_bf16 v[60:63], a[184:187], a[160:163], v[60:63]
    v_mfma_f32_16x16x32_bf16 v[64:67], a[188:191], a[160:163], v[64:67]
    s_waitcnt lgkmcnt(3)
    v_mfma_f32_16x16x32_bf16 v[28:31], a[192:195], a[164:167], v[28:31]
    ds_read_b64_tr_b16 a[184:185], v94 offset:16384
    ds_read_b64_tr_b16 a[186:187], v94 offset:17408
    ds_read_b64_tr_b16 a[188:189], v95 offset:16384
    v_mfma_f32_16x16x32_bf16 v[32:35], a[196:199], a[164:167], v[32:35]
    ds_read_b64_tr_b16 a[190:191], v95 offset:17408
    ds_read_b128 a[144:147], v92 offset:0
    ds_read_b128 a[148:151], v92 offset:4096
    v_mfma_f32_16x16x32_bf16 v[36:39], a[192:195], a[168:171], v[36:39]
    ds_read_b128 a[152:155], v92 offset:8192
    ds_read_b128 a[156:159], v92 offset:12288
    ds_read_b128 a[160:163], v92 offset:16384
    v_mfma_f32_16x16x32_bf16 v[40:43], a[196:199], a[168:171], v[40:43]
    s_waitcnt lgkmcnt(9)
    v_mfma_f32_16x16x32_bf16 v[44:47], a[192:195], a[172:175], v[44:47]
    v_mfma_f32_16x16x32_bf16 v[48:51], a[196:199], a[172:175], v[48:51]
    v_mfma_f32_16x16x32_bf16 v[52:55], a[192:195], a[176:179], v[52:55]
    v_mfma_f32_16x16x32_bf16 v[56:59], a[196:199], a[176:179], v[56:59]
    v_mfma_f32_16x16x32_bf16 v[60:63], a[192:195], a[180:183], v[60:63]
    v_mfma_f32_16x16x32_bf16 v[64:67], a[196:199], a[180:183], v[64:67]
    s_waitcnt lgkmcnt(3)
    v_mfma_f32_16x16x32_bf16 v[28:31], a[184:187], a[144:147], v[28:31]
    ds_read_b64_tr_b16 a[192:193], v94 offset:24576
    ds_read_b64_tr_b16 a[194:195], v94 offset:25600
    ds_read_b64_tr_b16 a[196:197], v95 offset:24576
    v_mfma_f32_16x16x32_bf16 v[32:35], a[188:191], a[144:147], v[32:35]
    ds_read_b64_tr_b16 a[198:199], v95 offset:25600
    ds_read_b128 a[164:167], v93 offset:0
    ds_read_b128 a[168:171], v93 offset:4096
    v_mfma_f32_16x16x32_bf16 v[36:39], a[184:187], a[148:151], v[36:39]
    ds_read_b128 a[172:175], v93 offset:8192
    ds_read_b128 a[176:179], v93 offset:12288
    ds_read_b128 a[180:183], v93 offset:16384
    v_mfma_f32_16x16x32_bf16 v[40:43], a[188:191], a[148:151], v[40:43]
    s_waitcnt lgkmcnt(9)
    s_add_u32 m0, s95, 12288
    s_add_u32 s57, s54, 49152
    buffer_load_dwordx4 v84, s[24:27], s57 offen lds
    v_mfma_f32_16x16x32_bf16 v[44:47], a[184:187], a[152:155], v[44:47]
    s_add_u32 m0, s95, 16384
    s_add_u32 s57, s54, 65536
    buffer_load_dwordx4 v84, s[24:27], s57 offen lds
    v_mfma_f32_16x16x32_bf16 v[48:51], a[188:191], a[152:155], v[48:51]
    s_add_u32 m0, s52, 20480
    s_add_u32 s57, s56, 0
    buffer_load_dwordx4 v88, s[28:31], s57 offen lds
    v_mfma_f32_16x16x32_bf16 v[52:55], a[184:187], a[156:159], v[52:55]
    s_add_u32 m0, s52, 21504
    s_add_u32 s57, s56, 32768
    buffer_load_dwordx4 v88, s[28:31], s57 offen lds
    v_mfma_f32_16x16x32_bf16 v[56:59], a[188:191], a[156:159], v[56:59]
    s_add_u32 m0, s52, 22528
    s_add_u32 s57, s56, 65536
    buffer_load_dwordx4 v89, s[28:31], s57 offen lds
    v_mfma_f32_16x16x32_bf16 v[60:63], a[184:187], a[160:163], v[60:63]
    v_mfma_f32_16x16x32_bf16 v[64:67], a[188:191], a[160:163], v[64:67]
    s_waitcnt lgkmcnt(3)
    v_mfma_f32_16x16x32_bf16 v[28:31], a[192:195], a[164:167], v[28:31]
    v_add_u32 v90, 53248, v90
    v_add_u32 v91, 53248, v91
    v_mfma_f32_16x16x32_bf16 v[32:35], a[196:199], a[164:167], v[32:35]
    v_add_u32 v92, 53248, v92
    v_add_u32 v93, 53248, v93
    v_mfma_f32_16x16x32_bf16 v[36:39], a[192:195], a[168:171], v[36:39]
    v_add_u32 v94, 53248, v94
    v_add_u32 v95, 53248, v95
    v_mfma_f32_16x16x32_bf16 v[40:43], a[196:199], a[168:171], v[40:43]
    s_waitcnt vmcnt(8) lgkmcnt(0)
    s_barrier
    v_mfma_f32_16x16x32_bf16 v[44:47], a[192:195], a[172:175], v[44:47]
    ds_read_b64_tr_b16 a[184:185], v94 offset:0
    ds_read_b64_tr_b16 a[186:187], v94 offset:1024
    ds_read_b64_tr_b16 a[188:189], v95 offset:0
    v_mfma_f32_16x16x32_bf16 v[48:51], a[196:199], a[172:175], v[48:51]
    ds_read_b64_tr_b16 a[190:191], v95 offset:1024
    ds_read_b128 a[144:147], v90 offset:0
    ds_read_b128 a[148:151], v90 offset:4096
    v_mfma_f32_16x16x32_bf16 v[52:55], a[192:195], a[176:179], v[52:55]
    ds_read_b128 a[152:155], v90 offset:8192
    ds_read_b128 a[156:159], v90 offset:12288
    ds_read_b128 a[160:163], v90 offset:16384
    v_mfma_f32_16x16x32_bf16 v[56:59], a[196:199], a[176:179], v[56:59]
    s_add_u32 m0, s52, 23552
    s_add_u32 s57, s56, 98304
    buffer_load_dwordx4 v89, s[28:31], s57 offen lds
    v_mfma_f32_16x16x32_bf16 v[60:63], a[192:195], a[180:183], v[60:63]
    s_add_u32 m0, s52, 24576
    s_add_u32 s57, s56, 131072
    buffer_load_dwordx4 v88, s[28:31], s57 offen lds
    v_mfma_f32_16x16x32_bf16 v[64:67], a[196:199], a[180:183], v[64:67]
    s_waitcnt lgkmcnt(3)
    s_add_u32 m0, s52, 25600
    s_add_u32 s57, s56, 163840
    buffer_load_dwordx4 v88, s[28:31], s57 offen lds
    v_mfma_f32_16x16x32_bf16 v[28:31], a[184:187], a[144:147], v[28:31]
    ds_read_b64_tr_b16 a[192:193], v94 offset:8192
    ds_read_b64_tr_b16 a[194:195], v94 offset:9216
    ds_read_b64_tr_b16 a[196:197], v95 offset:8192
    v_mfma_f32_16x16x32_bf16 v[32:35], a[188:191], a[144:147], v[32:35]
    ds_read_b64_tr_b16 a[198:199], v95 offset:9216
    ds_read_b128 a[164:167], v91 offset:0
    ds_read_b128 a[168:171], v91 offset:4096
    v_mfma_f32_16x16x32_bf16 v[36:39], a[184:187], a[148:151], v[36:39]
    ds_read_b128 a[172:175], v91 offset:8192
    ds_read_b128 a[176:179], v91 offset:12288
    ds_read_b128 a[180:183], v91 offset:16384
    v_mfma_f32_16x16x32_bf16 v[40:43], a[188:191], a[148:151], v[40:43]
    s_waitcnt lgkmcnt(9)
    s_add_u32 m0, s52, 26624
    s_add_u32 s57, s56, 196608
    buffer_load_dwordx4 v89, s[28:31], s57 offen lds
    v_mfma_f32_16x16x32_bf16 v[44:47], a[184:187], a[152:155], v[44:47]
    s_add_u32 m0, s52, 27648
    s_add_u32 s57, s56, 229376
    buffer_load_dwordx4 v89, s[28:31], s57 offen lds
    v_mfma_f32_16x16x32_bf16 v[48:51], a[188:191], a[152:155], v[48:51]
    s_bfe_u32 s48, s94, 262144
    s_lshl_b32 s48, s48, 13
    s_or_b32 s49, s48, 4096
    s_add_u32 m0, s52, 53248
    s_nop 0
    buffer_load_dwordx4 v20, s[32:35], s48 offen offset:0 lds
    v_mfma_f32_16x16x32_bf16 v[52:55], a[184:187], a[156:159], v[52:55]
    buffer_load_dwordx4 v20, s[32:35], s48 offen offset:1024 lds
    v_mfma_f32_16x16x32_bf16 v[56:59], a[188:191], a[156:159], v[56:59]
    buffer_load_dwordx4 v21, s[32:35], s48 offen offset:2048 lds
    v_mfma_f32_16x16x32_bf16 v[60:63], a[184:187], a[160:163], v[60:63]
    v_mfma_f32_16x16x32_bf16 v[64:67], a[188:191], a[160:163], v[64:67]
    s_waitcnt lgkmcnt(3)
    v_mfma_f32_16x16x32_bf16 v[28:31], a[192:195], a[164:167], v[28:31]
    ds_read_b64_tr_b16 a[184:185], v94 offset:16384
    ds_read_b64_tr_b16 a[186:187], v94 offset:17408
    ds_read_b64_tr_b16 a[188:189], v95 offset:16384
    v_mfma_f32_16x16x32_bf16 v[32:35], a[196:199], a[164:167], v[32:35]
    ds_read_b64_tr_b16 a[190:191], v95 offset:17408
    ds_read_b128 a[144:147], v92 offset:0
    ds_read_b128 a[148:151], v92 offset:4096
    v_mfma_f32_16x16x32_bf16 v[36:39], a[192:195], a[168:171], v[36:39]
    ds_read_b128 a[152:155], v92 offset:8192
    ds_read_b128 a[156:159], v92 offset:12288
    ds_read_b128 a[160:163], v92 offset:16384
    v_mfma_f32_16x16x32_bf16 v[40:43], a[196:199], a[168:171], v[40:43]
    s_waitcnt lgkmcnt(9)
    v_mfma_f32_16x16x32_bf16 v[44:47], a[192:195], a[172:175], v[44:47]
    v_mfma_f32_16x16x32_bf16 v[48:51], a[196:199], a[172:175], v[48:51]
    v_mfma_f32_16x16x32_bf16 v[52:55], a[192:195], a[176:179], v[52:55]
    v_mfma_f32_16x16x32_bf16 v[56:59], a[196:199], a[176:179], v[56:59]
    v_mfma_f32_16x16x32_bf16 v[60:63], a[192:195], a[180:183], v[60:63]
    v_mfma_f32_16x16x32_bf16 v[64:67], a[196:199], a[180:183], v[64:67]
    s_waitcnt lgkmcnt(3)
    v_mfma_f32_16x16x32_bf16 v[28:31], a[184:187], a[144:147], v[28:31]
    ds_read_b64_tr_b16 a[192:193], v94 offset:24576
    ds_read_b64_tr_b16 a[194:195], v94 offset:25600
    ds_read_b64_tr_b16 a[196:197], v95 offset:24576
    v_mfma_f32_16x16x32_bf16 v[32:35], a[188:191], a[144:147], v[32:35]
    ds_read_b64_tr_b16 a[198:199], v95 offset:25600
    ds_read_b128 a[164:167], v93 offset:0
    ds_read_b128 a[168:171], v93 offset:4096
    v_mfma_f32_16x16x32_bf16 v[36:39], a[184:187], a[148:151], v[36:39]
    ds_read_b128 a[172:175], v93 offset:8192
    ds_read_b128 a[176:179], v93 offset:12288
    ds_read_b128 a[180:183], v93 offset:16384
    v_mfma_f32_16x16x32_bf16 v[40:43], a[188:191], a[148:151], v[40:43]
    s_waitcnt lgkmcnt(9)
    buffer_load_dwordx4 v21, s[32:35], s48 offen offset:3072 lds
    v_mfma_f32_16x16x32_bf16 v[44:47], a[184:187], a[152:155], v[44:47]
    s_add_u32 m0, s52, 57344
    s_nop 0
    buffer_load_dwordx4 v22, s[32:35], s49 offen offset:0 lds
    v_mfma_f32_16x16x32_bf16 v[48:51], a[188:191], a[152:155], v[48:51]
    buffer_load_dwordx4 v22, s[32:35], s49 offen offset:1024 lds
    v_mfma_f32_16x16x32_bf16 v[52:55], a[184:187], a[156:159], v[52:55]
    buffer_load_dwordx4 v23, s[32:35], s49 offen offset:2048 lds
    v_mfma_f32_16x16x32_bf16 v[56:59], a[188:191], a[156:159], v[56:59]
    buffer_load_dwordx4 v23, s[32:35], s49 offen offset:3072 lds
    v_mfma_f32_16x16x32_bf16 v[60:63], a[184:187], a[160:163], v[60:63]
    s_mov_b64 exec, 1
    v_mov_b32 v2, s63
    global_store_dwordx2 v2, v[76:77], s[18:19] sc1
    s_mov_b64 exec, -1
    v_mfma_f32_16x16x32_bf16 v[64:67], a[188:191], a[160:163], v[64:67]
    s_waitcnt lgkmcnt(3)
    v_mfma_f32_16x16x32_bf16 v[28:31], a[192:195], a[164:167], v[28:31]
    v_add_u32 v90, -106496, v90
    v_add_u32 v91, -106496, v91
    v_mfma_f32_16x16x32_bf16 v[32:35], a[196:199], a[164:167], v[32:35]
    v_add_u32 v92, -106496, v92
    v_add_u32 v93, -106496, v93
    v_mfma_f32_16x16x32_bf16 v[36:39], a[192:195], a[168:171], v[36:39]
    v_add_u32 v94, -106496, v94
    v_add_u32 v95, -106496, v95
    v_mfma_f32_16x16x32_bf16 v[40:43], a[196:199], a[168:171], v[40:43]
    s_waitcnt vmcnt(9) lgkmcnt(0)
    s_barrier
    v_mfma_f32_16x16x32_bf16 v[44:47], a[192:195], a[172:175], v[44:47]
    ds_read_b64_tr_b16 a[112:113], v94 offset:0
    ds_read_b64_tr_b16 a[114:115], v94 offset:1024
    ds_read_b64_tr_b16 a[116:117], v95 offset:0
    v_mfma_f32_16x16x32_bf16 v[48:51], a[196:199], a[172:175], v[48:51]
    ds_read_b64_tr_b16 a[118:119], v95 offset:1024
    ds_read_b128 a[0:3], v90 offset:0
    ds_read_b64_tr_b16 a[120:121], v94 offset:8192
    v_mfma_f32_16x16x32_bf16 v[52:55], a[192:195], a[176:179], v[52:55]
    ds_read_b64_tr_b16 a[122:123], v94 offset:9216
    ds_read_b64_tr_b16 a[124:125], v95 offset:8192
    ds_read_b64_tr_b16 a[126:127], v95 offset:9216
    v_mfma_f32_16x16x32_bf16 v[56:59], a[196:199], a[176:179], v[56:59]
    ds_read_b128 a[4:7], v91 offset:0
    ds_read_b64_tr_b16 a[128:129], v94 offset:16384
    ds_read_b64_tr_b16 a[130:131], v94 offset:17408
    v_mfma_f32_16x16x32_bf16 v[60:63], a[192:195], a[180:183], v[60:63]
    ds_read_b64_tr_b16 a[132:133], v95 offset:16384
    ds_read_b64_tr_b16 a[134:135], v95 offset:17408
    ds_read_b128 a[8:11], v92 offset:0
    v_mfma_f32_16x16x32_bf16 v[64:67], a[196:199], a[180:183], v[64:67]
    s_waitcnt lgkmcnt(10)
    s_bfe_u32 s48, s94, 262148
    s_lshl_b32 s48, s48, 13
    s_or_b32 s49, s48, 4096
    s_add_u32 m0, s52, 86016
    s_nop 0
    buffer_load_dwordx4 v20, s[32:35], s48 offen offset:0 lds
    v_mfma_f32_16x16x32_bf16 v[28:31], a[112:115], a[0:3], v[28:31]
    ds_read_b64_tr_b16 a[136:137], v94 offset:24576
    ds_read_b64_tr_b16 a[138:139], v94 offset:25600
    ds_read_b64_tr_b16 a[140:141], v95 offset:24576
    v_mfma_f32_16x16x32_bf16 v[32:35], a[116:119], a[0:3], v[32:35]
    ds_read_b64_tr_b16 a[142:143], v95 offset:25600
    ds_read_b128 a[12:15], v93 offset:0
    s_waitcnt lgkmcnt(10)
    v_mfma_f32_16x16x32_bf16 v[28:31], a[120:123], a[4:7], v[28:31]
    ds_read_b128 a[16:19], v90 offset:4096
    ds_read_b128 a[20:23], v91 offset:4096
    v_mfma_f32_16x16x32_bf16 v[32:35], a[124:127], a[4:7], v[32:35]
    s_waitcnt lgkmcnt(7)
    ds_read_b128 a[24:27], v92 offset:4096
    ds_read_b128 a[28:31], v93 offset:4096
    v_mfma_f32_16x16x32_bf16 v[28:31], a[128:131], a[8:11], v[28:31]
    buffer_load_dwordx4 v20, s[32:35], s48 offen offset:1024 lds
    v_mfma_f32_16x16x32_bf16 v[32:35], a[132:135], a[8:11], v[32:35]
    s_waitcnt lgkmcnt(4)
    s_barrier
    v_mfma_f32_16x16x32_bf16 v[28:31], a[136:139], a[12:15], v[28:31]
    v_mfma_f32_16x16x32_bf16 v[32:35], a[140:143], a[12:15], v[32:35]
    s_waitcnt lgkmcnt(0)
    v_mfma_f32_16x16x32_bf16 v[36:39], a[112:115], a[16:19], v[36:39]
    ds_read_b128 a[32:35], v90 offset:8192
    buffer_load_dwordx4 v21, s[32:35], s48 offen offset:2048 lds
    v_mfma_f32_16x16x32_bf16 v[40:43], a[116:119], a[16:19], v[40:43]
    ds_read_b128 a[36:39], v91 offset:8192
    v_mfma_f32_16x16x32_bf16 v[36:39], a[120:123], a[20:23], v[36:39]
    ds_read_b128 a[40:43], v92 offset:8192
    v_mul_f32 v28, s96, v28
    v_mul_f32 v29, s96, v29
    v_mul_f32 v30, s96, v30
    v_mfma_f32_16x16x32_bf16 v[40:43], a[124:127], a[20:23], v[40:43]
    ds_read_b128 a[44:47], v93 offset:8192
    v_mul_f32 v31, s96, v31
    v_cvt_pk_bf16_f32 v28, v28, v29
    v_cvt_pk_bf16_f32 v29, v30, v31
    v_mfma_f32_16x16x32_bf16 v[36:39], a[128:131], a[24:27], v[36:39]
    buffer_load_dwordx4 v21, s[32:35], s48 offen offset:3072 lds
    ds_write_b64 v73, v[28:29] offset:0
    v_mul_f32 v32, s96, v32
    v_mul_f32 v33, s96, v33
    v_mfma_f32_16x16x32_bf16 v[40:43], a[132:135], a[24:27], v[40:43]
    v_mul_f32 v34, s96, v34
    v_mul_f32 v35, s96, v35
    v_cvt_pk_bf16_f32 v32, v32, v33
    v_mfma_f32_16x16x32_bf16 v[36:39], a[136:139], a[28:31], v[36:39]
    v_cvt_pk_bf16_f32 v33, v34, v35
    ds_write_b64 v74, v[32:33] offset:0
    v_mfma_f32_16x16x32_bf16 v[40:43], a[140:143], a[28:31], v[40:43]
    s_waitcnt lgkmcnt(2)
    v_mfma_f32_16x16x32_bf16 v[44:47], a[112:115], a[32:35], v[44:47]
    ds_read_b128 a[48:51], v90 offset:12288
    s_add_u32 m0, s52, 90112
    s_nop 0
    buffer_load_dwordx4 v22, s[32:35], s49 offen offset:0 lds
    v_mfma_f32_16x16x32_bf16 v[48:51], a[116:119], a[32:35], v[48:51]
    ds_read_b128 a[52:55], v91 offset:12288
    v_mfma_f32_16x16x32_bf16 v[44:47], a[120:123], a[36:39], v[44:47]
    ds_read_b128 a[56:59], v92 offset:12288
    v_mul_f32 v36, s96, v36
    v_mul_f32 v37, s96, v37
    v_mul_f32 v38, s96, v38
    v_mfma_f32_16x16x32_bf16 v[48:51], a[124:127], a[36:39], v[48:51]
    ds_read_b128 a[60:63], v93 offset:12288
    v_mul_f32 v39, s96, v39
    v_cvt_pk_bf16_f32 v36, v36, v37
    v_cvt_pk_bf16_f32 v37, v38, v39
    v_mfma_f32_16x16x32_bf16 v[44:47], a[128:131], a[40:43], v[44:47]
    buffer_load_dwordx4 v22, s[32:35], s49 offen offset:1024 lds
    ds_write_b64 v73, v[36:37] offset:4096
    v_mul_f32 v40, s96, v40
    v_mul_f32 v41, s96, v41
    v_mfma_f32_16x16x32_bf16 v[48:51], a[132:135], a[40:43], v[48:51]
    v_mul_f32 v42, s96, v42
    v_mul_f32 v43, s96, v43
    v_cvt_pk_bf16_f32 v40, v40, v41
    v_mfma_f32_16x16x32_bf16 v[44:47], a[136:139], a[44:47], v[44:47]
    v_cvt_pk_bf16_f32 v41, v42, v43
    ds_write_b64 v74, v[40:41] offset:4096
    v_mfma_f32_16x16x32_bf16 v[48:51], a[140:143], a[44:47], v[48:51]
    s_waitcnt lgkmcnt(2)
    v_mfma_f32_16x16x32_bf16 v[52:55], a[112:115], a[48:51], v[52:55]
    ds_read_b128 a[64:67], v90 offset:16384
    buffer_load_dwordx4 v23, s[32:35], s49 offen offset:2048 lds
    v_mfma_f32_16x16x32_bf16 v[56:59], a[116:119], a[48:51], v[56:59]
    ds_read_b128 a[68:71], v91 offset:16384
    v_mfma_f32_16x16x32_bf16 v[52:55], a[120:123], a[52:55], v[52:55]
    ds_read_b128 a[72:75], v92 offset:16384
    v_mul_f32 v44, s96, v44
    v_mul_f32 v45, s96, v45
    v_mul_f32 v46, s96, v46
    v_mfma_f32_16x16x32_bf16 v[56:59], a[124:127], a[52:55], v[56:59]
    ds_read_b128 a[76:79], v93 offset:16384
    v_mul_f32 v47, s96, v47
    v_cvt_pk_bf16_f32 v44, v44, v45
    v_cvt_pk_bf16_f32 v45, v46, v47
    v_mfma_f32_16x16x32_bf16 v[52:55], a[128:131], a[56:59], v[52:55]
    buffer_load_dwordx4 v23, s[32:35], s49 offen offset:3072 lds
    ds_write_b64 v73, v[44:45] offset:8192
    v_mul_f32 v48, s96, v48
    v_mul_f32 v49, s96, v49
    v_mfma_f32_16x16x32_bf16 v[56:59], a[132:135], a[56:59], v[56:59]
    v_mul_f32 v50, s96, v50
    v_mul_f32 v51, s96, v51
    v_cvt_pk_bf16_f32 v48, v48, v49
    v_mfma_f32_16x16x32_bf16 v[52:55], a[136:139], a[60:63], v[52:55]
    v_cvt_pk_bf16_f32 v49, v50, v51
    ds_write_b64 v74, v[48:49] offset:8192
    v_mfma_f32_16x16x32_bf16 v[56:59], a[140:143], a[60:63], v[56:59]
    s_waitcnt lgkmcnt(2)
    v_mfma_f32_16x16x32_bf16 v[60:63], a[112:115], a[64:67], v[60:63]
    s_bfe_u32 s50, s94, 262144
    s_lshl_b32 s50, s50, 13
    s_or_b32 s51, s50, 4096
    s_add_u32 m0, s52, 118784
    s_nop 0
    buffer_load_dwordx4 v24, s[36:39], s50 offen offset:0 lds
    v_mfma_f32_16x16x32_bf16 v[64:67], a[116:119], a[64:67], v[64:67]
    v_mfma_f32_16x16x32_bf16 v[60:63], a[120:123], a[68:71], v[60:63]
    v_mul_f32 v52, s96, v52
    v_mul_f32 v53, s96, v53
    v_mul_f32 v54, s96, v54
    v_mfma_f32_16x16x32_bf16 v[64:67], a[124:127], a[68:71], v[64:67]
    v_mul_f32 v55, s96, v55
    v_cvt_pk_bf16_f32 v52, v52, v53
    v_cvt_pk_bf16_f32 v53, v54, v55
    ds_write_b64 v73, v[52:53] offset:12288
    v_mfma_f32_16x16x32_bf16 v[60:63], a[128:131], a[72:75], v[60:63]
    buffer_load_dwordx4 v24, s[36:39], s50 offen offset:1024 lds
    v_mul_f32 v56, s96, v56
    v_mul_f32 v57, s96, v57
    v_mul_f32 v58, s96, v58
    v_mfma_f32_16x16x32_bf16 v[64:67], a[132:135], a[72:75], v[64:67]
    v_mul_f32 v59, s96, v59
    v_cvt_pk_bf16_f32 v56, v56, v57
    v_cvt_pk_bf16_f32 v57, v58, v59
    ds_write_b64 v74, v[56:57] offset:12288
    v_mfma_f32_16x16x32_bf16 v[60:63], a[136:139], a[76:79], v[60:63]
    v_mfma_f32_16x16x32_bf16 v[64:67], a[140:143], a[76:79], v[64:67]
    v_add_u32 v90, 32768, v90
    v_add_u32 v91, 32768, v91
    v_add_u32 v92, 32768, v92
    v_add_u32 v93, 32768, v93
    s_mov_b32 s28, s16
    s_mov_b32 s29, s17
    s_mov_b32 s30, 256
    s_mov_b32 s31, 0x20000
    v_mul_f32 v60, s96, v60
    v_mul_f32 v61, s96, v61
    v_mul_f32 v62, s96, v62
    v_mul_f32 v63, s96, v63
    v_cvt_pk_bf16_f32 v60, v60, v61
    v_cvt_pk_bf16_f32 v61, v62, v63
    ds_write_b64 v73, v[60:61] offset:16384
    v_mul_f32 v64, s96, v64
    v_mul_f32 v65, s96, v65
    v_mul_f32 v66, s96, v66
    v_mul_f32 v67, s96, v67
    v_cvt_pk_bf16_f32 v64, v64, v65
    v_cvt_pk_bf16_f32 v65, v66, v67
    ds_write_b64 v74, v[64:65] offset:16384
    buffer_load_dwordx4 v25, s[36:39], s50 offen offset:2048 lds
    buffer_load_dwordx4 v25, s[36:39], s50 offen offset:3072 lds
    s_waitcnt vmcnt(12) lgkmcnt(0)
    s_barrier
    ds_read_b128 a[0:3], v90 offset:0
    ds_read_b128 a[4:7], v91 offset:0
    ds_read_b128 a[8:11], v92 offset:0
    ds_read_b128 a[12:15], v93 offset:0
    s_waitcnt vmcnt(13)
    ds_read_b128 a[80:83], v8 offset:0
    ds_read_b128 a[84:87], v9 offset:0
    ds_read_b128 a[88:91], v10 offset:0
    ds_read_b128 a[92:95], v11 offset:0
    ds_read_b128 a[96:99], v8 offset:1024
    ds_read_b128 a[100:103], v9 offset:1024
    ds_read_b128 a[104:107], v10 offset:1024
    ds_read_b128 a[108:111], v11 offset:1024
    v_mov_b32 v64, 0
    v_mov_b32 v65, 0
    v_mov_b32 v66, 0
    v_mov_b32 v67, 0
    v_mov_b32 v68, 0
    v_mov_b32 v69, 0
    v_mov_b32 v70, 0
    v_mov_b32 v71, 0
    v_mov_b32 v72, 0
    v_mov_b32 v73, 0
    v_mov_b32 v74, 0
    v_mov_b32 v75, 0
    v_mov_b32 v76, 0
    v_mov_b32 v77, 0
    v_mov_b32 v78, 0
    v_mov_b32 v79, 0
    v_mov_b32 v80, 0
    v_mov_b32 v81, 0
    v_mov_b32 v82, 0
    v_mov_b32 v83, 0
    s_lshl_b32 s55, s21, 5
    s_cmp_eq_u32 s23, -1
    s_cbranch_scc1 L_rowmax
    s_cmp_lg_u32 s3, 0
    s_cbranch_scc1 L_noat
    s_mov_b64 exec, 1
    v_mov_b32 v1, 1
    v_mov_b32 v2, 0
    buffer_atomic_add v1, v2, s[28:31], s55 offen sc1
    s_mov_b64 exec, -1
L_noat:
    s_waitcnt lgkmcnt(8)
    ds_read_b128 a[16:19], v90 offset:4096
    ds_read_b128 a[20:23], v91 offset:4096
    ds_read_b128 a[24:27], v92 offset:4096
    ds_read_b128 a[28:31], v93 offset:4096
    s_waitcnt lgkmcnt(4)
    ds_read_b128 a[32:35], v90 offset:8192
    ds_read_b128 a[36:39], v91 offset:8192
    ds_read_b128 a[40:43], v92 offset:8192
    ds_read_b128 a[44:47], v93 offset:8192
    ds_read_b128 a[48:51], v90 offset:12288
    ds_read_b128 a[52:55], v91 offset:12288
    ds_read_b128 a[56:59], v92 offset:12288
    ds_read_b128 a[60:63], v93 offset:12288
    v_mfma_f32_16x16x32_bf16 v[56:59], a[80:83], a[0:3], v[64:67]
    s_add_u32 m0, s52, 122880
    s_nop 0
    buffer_load_dwordx4 v24, s[36:39], s51 offen offset:0 lds
    v_mfma_f32_16x16x32_bf16 v[56:59], a[84:87], a[4:7], v[56:59]
    buffer_load_dwordx4 v24, s[36:39], s51 offen offset:1024 lds
    v_mfma_f32_16x16x32_bf16 v[56:59], a[88:91], a[8:11], v[56:59]
    buffer_load_dwordx4 v25, s[36:39], s51 offen offset:2048 lds
    v_mfma_f32_16x16x32_bf16 v[56:59], a[92:95], a[12:15], v[56:59]
    buffer_load_dwordx4 v25, s[36:39], s51 offen offset:3072 lds
    s_waitcnt lgkmcnt(8)
    ds_read_b128 a[64:67], v90 offset:16384
    ds_read_b128 a[68:71], v91 offset:16384
    ds_read_b128 a[72:75], v92 offset:16384
    ds_read_b128 a[76:79], v93 offset:16384
    v_mfma_f32_16x16x32_bf16 v[60:63], a[96:99], a[0:3], v[64:67]
    s_bfe_u32 s50, s94, 262148
    s_lshl_b32 s50, s50, 13
    s_or_b32 s51, s50, 4096
    s_add_u32 m0, s52, 0
    s_nop 0
    buffer_load_dwordx4 v24, s[36:39], s50 offen offset:0 lds
    v_mfma_f32_16x16x32_bf16 v[60:63], a[100:103], a[4:7], v[60:63]
    buffer_load_dwordx4 v24, s[36:39], s50 offen offset:1024 lds
    v_mfma_f32_16x16x32_bf16 v[60:63], a[104:107], a[8:11], v[60:63]
    buffer_load_dwordx4 v25, s[36:39], s50 offen offset:2048 lds
    v_mfma_f32_16x16x32_bf16 v[60:63], a[108:111], a[12:15], v[60:63]
    buffer_load_dwordx4 v25, s[36:39], s50 offen offset:3072 lds
    s_waitcnt lgkmcnt(12)
    v_add_u32 v84, 118784, v12
    v_add_u32 v85, 118784, v13
    v_add_u32 v86, 118784, v14
    v_add_u32 v87, 118784, v15
    v_add_u32 v88, 118784, v16
    v_add_u32 v89, 118784, v17
    v_add_u32 v90, 118784, v18
    v_add_u32 v91, 118784, v19
    v_mov_b32 v92, -1
    v_mov_b32 v93, -1
    v_mov_b32 v94, -1
    v_mov_b32 v95, -1
    v_mfma_f32_16x16x32_bf16 v[48:51], a[80:83], a[16:19], v[68:71]
    s_add_u32 m0, s52, 4096
    s_nop 0
    buffer_load_dwordx4 v24, s[36:39], s51 offen offset:0 lds
    v_exp_f32 v56, v56
    v_mfma_f32_16x16x32_bf16 v[48:51], a[84:87], a[20:23], v[48:51]
    v_exp_f32 v57, v57
    v_mfma_f32_16x16x32_bf16 v[48:51], a[88:91], a[24:27], v[48:51]
    buffer_load_dwordx4 v24, s[36:39], s51 offen offset:1024 lds
    v_exp_f32 v58, v58
    v_cvt_pk_bf16_f32 v28, v56, v57
    v_mfma_f32_16x16x32_bf16 v[48:51], a[92:95], a[28:31], v[48:51]
    v_exp_f32 v59, v59
    v_mfma_f32_16x16x32_bf16 v[52:55], a[96:99], a[16:19], v[68:71]
    buffer_load_dwordx4 v25, s[36:39], s51 offen offset:2048 lds
    v_exp_f32 v60, v60
    v_cvt_pk_bf16_f32 v29, v58, v59
    v_mfma_f32_16x16x32_bf16 v[52:55], a[100:103], a[20:23], v[52:55]
    v_exp_f32 v61, v61
    v_mfma_f32_16x16x32_bf16 v[52:55], a[104:107], a[24:27], v[52:55]
    buffer_load_dwordx4 v25, s[36:39], s51 offen offset:3072 lds
    v_exp_f32 v62, v62
    v_cvt_pk_bf16_f32 v30, v60, v61
    v_mfma_f32_16x16x32_bf16 v[52:55], a[108:111], a[28:31], v[52:55]
    v_exp_f32 v63, v63
    s_nop 0
    v_cvt_pk_bf16_f32 v31, v62, v63
    s_waitcnt lgkmcnt(8)
    v_mfma_f32_16x16x32_bf16 v[56:59], a[80:83], a[32:35], v[72:75]
    s_bfe_u32 s48, s94, 262152
    s_lshl_b32 s48, s48, 13
    s_or_b32 s49, s48, 4096
    s_add_u32 m0, s52, 53248
    s_nop 0
    buffer_load_dwordx4 v20, s[32:35], s48 offen offset:0 lds
    v_exp_f32 v48, v48
    v_mfma_f32_16x16x32_bf16 v[56:59], a[84:87], a[36:39], v[56:59]
    s_waitcnt vmcnt(17)
    v_exp_f32 v49, v49
    ds_read_b128 a[112:115], v8 offset:32768
    ds_read_b128 a[116:119], v9 offset:32768
    v_mfma_f32_16x16x32_bf16 v[56:59], a[88:91], a[40:43], v[56:59]
    buffer_load_dwordx4 v20, s[32:35], s48 offen offset:1024 lds
    v_exp_f32 v50, v50
    v_cvt_pk_bf16_f32 v32, v48, v49
    v_mfma_f32_16x16x32_bf16 v[56:59], a[92:95], a[44:47], v[56:59]
    v_exp_f32 v51, v51
    ds_read_b128 a[120:123], v10 offset:32768
    ds_read_b128 a[124:127], v11 offset:32768
    v_mfma_f32_16x16x32_bf16 v[60:63], a[96:99], a[32:35], v[72:75]
    buffer_load_dwordx4 v21, s[32:35], s48 offen offset:2048 lds
    v_exp_f32 v52, v52
    v_cvt_pk_bf16_f32 v33, v50, v51
    v_mfma_f32_16x16x32_bf16 v[60:63], a[100:103], a[36:39], v[60:63]
    v_exp_f32 v53, v53
    ds_read_b128 a[128:131], v8 offset:33792
    ds_read_b128 a[132:135], v9 offset:33792
    v_mfma_f32_16x16x32_bf16 v[60:63], a[104:107], a[40:43], v[60:63]
    buffer_load_dwordx4 v21, s[32:35], s48 offen offset:3072 lds
    v_exp_f32 v54, v54
    v_cvt_pk_bf16_f32 v34, v52, v53
    v_mfma_f32_16x16x32_bf16 v[60:63], a[108:111], a[44:47], v[60:63]
    v_exp_f32 v55, v55
    s_nop 0
    v_cvt_pk_bf16_f32 v35, v54, v55
    ds_read_b128 a[136:139], v10 offset:33792
    ds_read_b128 a[140:143], v11 offset:33792
    s_waitcnt lgkmcnt(12)
    v_mfma_f32_16x16x32_bf16 v[48:51], a[80:83], a[48:51], v[76:79]
    s_add_u32 m0, s52, 57344
    s_nop 0
    buffer_load_dwordx4 v22, s[32:35], s49 offen offset:0 lds
    v_exp_f32 v56, v56
    v_mfma_f32_16x16x32_bf16 v[48:51], a[84:87], a[52:55], v[48:51]
    s_waitcnt vmcnt(13)
    v_exp_f32 v57, v57
    ds_read_b64_tr_b16 a[144:145], v84 offset:0
    ds_read_b64_tr_b16 a[146:147], v84 offset:1024
    v_mfma_f32_16x16x32_bf16 v[48:51], a[88:91], a[56:59], v[48:51]
    buffer_load_dwordx4 v22, s[32:35], s49 offen offset:1024 lds
    v_exp_f32 v58, v58
    v_cvt_pk_bf16_f32 v36, v56, v57
    v_mfma_f32_16x16x32_bf16 v[48:51], a[92:95], a[60:63], v[48:51]
    v_exp_f32 v59, v59
    ds_read_b64_tr_b16 a[148:149], v85 offset:0
    ds_read_b64_tr_b16 a[150:151], v85 offset:1024
    v_mfma_f32_16x16x32_bf16 v[52:55], a[96:99], a[48:51], v[76:79]
    buffer_load_dwordx4 v23, s[32:35], s49 offen offset:2048 lds
    v_exp_f32 v60, v60
    v_cvt_pk_bf16_f32 v37, v58, v59
    v_mfma_f32_16x16x32_bf16 v[52:55], a[100:103], a[52:55], v[52:55]
    v_exp_f32 v61, v61
    ds_read_b64_tr_b16 a[152:153], v86 offset:0
    ds_read_b64_tr_b16 a[154:155], v86 offset:1024
    v_mfma_f32_16x16x32_bf16 v[52:55], a[104:107], a[56:59], v[52:55]
    buffer_load_dwordx4 v23, s[32:35], s49 offen offset:3072 lds
    v_exp_f32 v62, v62
    v_cvt_pk_bf16_f32 v38, v60, v61
    v_mfma_f32_16x16x32_bf16 v[52:55], a[108:111], a[60:63], v[52:55]
    v_exp_f32 v63, v63
    s_nop 0
    v_cvt_pk_bf16_f32 v39, v62, v63
    ds_read_b64_tr_b16 a[156:157], v87 offset:0
    ds_read_b64_tr_b16 a[158:159], v87 offset:1024
    s_waitcnt lgkmcnt(15)
    v_mfma_f32_16x16x32_bf16 v[56:59], a[80:83], a[64:67], v[80:83]
    v_exp_f32 v48, v48
    v_mfma_f32_16x16x32_bf16 v[56:59], a[84:87], a[68:71], v[56:59]
    v_exp_f32 v49, v49
    ds_read_b64_tr_b16 a[160:161], v88 offset:0
    ds_read_b64_tr_b16 a[162:163], v88 offset:1024
    v_mfma_f32_16x16x32_bf16 v[56:59], a[88:91], a[72:75], v[56:59]
    v_exp_f32 v50, v50
    v_cvt_pk_bf16_f32 v40, v48, v49
    v_mfma_f32_16x16x32_bf16 v[56:59], a[92:95], a[76:79], v[56:59]
    v_exp_f32 v51, v51
    ds_read_b64_tr_b16 a[164:165], v89 offset:0
    ds_read_b64_tr_b16 a[166:167], v89 offset:1024
    v_mfma_f32_16x16x32_bf16 v[60:63], a[96:99], a[64:67], v[80:83]
    v_exp_f32 v52, v52
    v_cvt_pk_bf16_f32 v41, v50, v51
    v_mfma_f32_16x16x32_bf16 v[60:63], a[100:103], a[68:71], v[60:63]
    v_exp_f32 v53, v53
    ds_read_b64_tr_b16 a[168:169], v90 offset:0
    ds_read_b64_tr_b16 a[170:171], v90 offset:1024
    v_mfma_f32_16x16x32_bf16 v[60:63], a[104:107], a[72:75], v[60:63]
    v_exp_f32 v54, v54
    v_cvt_pk_bf16_f32 v42, v52, v53
    v_mfma_f32_16x16x32_bf16 v[60:63], a[108:111], a[76:79], v[60:63]
    v_exp_f32 v55, v55
    s_nop 0
    v_cvt_pk_bf16_f32 v43, v54, v55
    ds_read_b64_tr_b16 a[172:173], v91 offset:0
    ds_read_b64_tr_b16 a[174:175], v91 offset:1024
    s_mov_b32 s53, 0
    s_bfe_u32 s48, s94, 262156
    s_lshl_b32 s48, s48, 13
    s_or_b32 s49, s48, 4096
    s_bfe_u32 s50, s94, 262152
    s_lshl_b32 s50, s50, 13
    s_or_b32 s51, s50, 4096
    s_waitcnt lgkmcnt(0)
.p2align 6
L_loop:
    v_mfma_f32_16x16x32_bf16 v[48:51], a[112:115], a[0:3], v[64:67]
    v_exp_f32 v56, v56
    v_mfma_f32_16x16x32_bf16 v[48:51], a[116:119], a[4:7], v[48:51]
    s_lshr_b32 s93, s93, 3
    v_mfma_f32_16x16x32_bf16 v[48:51], a[120:123], a[8:11], v[48:51]
    v_exp_f32 v57, v57
    v_mfma_f32_16x16x32_bf16 v[48:51], a[124:127], a[12:15], v[48:51]
    v_cvt_pk_bf16_f32 v44, v56, v57
    v_mfma_f32_16x16x32_bf16 v[52:55], a[128:131], a[0:3], v[64:67]
    v_exp_f32 v58, v58
    v_mfma_f32_16x16x32_bf16 v[52:55], a[132:135], a[4:7], v[52:55]
    s_add_u32 m0, s52, 118784
    v_mfma_f32_16x16x32_bf16 v[52:55], a[136:139], a[8:11], v[52:55]
    v_exp_f32 v59, v59
    v_mfma_f32_16x16x32_bf16 v[52:55], a[140:143], a[12:15], v[52:55]
    v_cvt_pk_bf16_f32 v45, v58, v59
    v_mfma_f32_16x16x32_bf16 v[96:99], a[144:147], v[28:31], v[96:99]
    v_exp_f32 v60, v60
    v_mfma_f32_16x16x32_bf16 v[116:119], a[148:151], v[28:31], v[116:119]
    buffer_load_dwordx4 v24, s[36:39], s50 offen offset:0 lds
    v_mfma_f32_16x16x32_bf16 v[136:139], a[152:155], v[28:31], v[136:139]
    v_exp_f32 v61, v61
    v_mfma_f32_16x16x32_bf16 v[156:159], a[156:159], v[28:31], v[156:159]
    v_cvt_pk_bf16_f32 v46, v60, v61
    v_mfma_f32_16x16x32_bf16 v[176:179], a[160:163], v[28:31], v[176:179]
    v_exp_f32 v62, v62
    v_mfma_f32_16x16x32_bf16 v[196:199], a[164:167], v[28:31], v[196:199]
    buffer_load_dwordx4 v24, s[36:39], s50 offen offset:1024 lds
    v_mfma_f32_16x16x32_bf16 v[216:219], a[168:171], v[28:31], v[216:219]
    v_exp_f32 v63, v63
    v_mfma_f32_16x16x32_bf16 v[236:239], a[172:175], v[28:31], v[236:239]
    v_cvt_pk_bf16_f32 v47, v62, v63
    v_mfma_f32_16x16x32_bf16 a[208:211], a[248:251], v[28:31], a[208:211]
    s_lshr_b32 s90, s90, 3
    v_mfma_f32_16x16x32_bf16 v[56:59], a[112:115], a[16:19], v[68:71]
    v_exp_f32 v48, v48
    v_mfma_f32_16x16x32_bf16 v[56:59], a[116:119], a[20:23], v[56:59]
    buffer_load_dwordx4 v25, s[36:39], s50 offen offset:2048 lds
    v_mfma_f32_16x16x32_bf16 v[56:59], a[120:123], a[24:27], v[56:59]
    v_exp_f32 v49, v49
    v_mfma_f32_16x16x32_bf16 v[56:59], a[124:127], a[28:31], v[56:59]
    v_cvt_pk_bf16_f32 v28, v48, v49
    v_mfma_f32_16x16x32_bf16 v[60:63], a[128:131], a[16:19], v[68:71]
    v_exp_f32 v50, v50
    v_mfma_f32_16x16x32_bf16 v[60:63], a[132:135], a[20:23], v[60:63]
    buffer_load_dwordx4 v25, s[36:39], s50 offen offset:3072 lds
    v_mfma_f32_16x16x32_bf16 v[60:63], a[136:139], a[24:27], v[60:63]
    v_exp_f32 v51, v51
    v_mfma_f32_16x16x32_bf16 v[60:63], a[140:143], a[28:31], v[60:63]
    s_add_u32 m0, s52, 122880
    v_cvt_pk_bf16_f32 v29, v50, v51
    v_mfma_f32_16x16x32_bf16 v[100:103], a[144:147], v[32:35], v[100:103]
    v_exp_f32 v52, v52
    v_mfma_f32_16x16x32_bf16 v[120:123], a[148:151], v[32:35], v[120:123]
    buffer_load_dwordx4 v24, s[36:39], s51 offen offset:0 lds
    v_mfma_f32_16x16x32_bf16 v[140:143], a[152:155], v[32:35], v[140:143]
    v_exp_f32 v53, v53
    v_mfma_f32_16x16x32_bf16 v[160:163], a[156:159], v[32:35], v[160:163]
    s_waitcnt vmcnt(13)
    ds_read_b64_tr_b16 a[176:177], v12 offset:0
    v_cvt_pk_bf16_f32 v30, v52, v53
    v_mfma_f32_16x16x32_bf16 v[180:183], a[160:163], v[32:35], v[180:183]
    v_exp_f32 v54, v54
    v_mfma_f32_16x16x32_bf16 v[200:203], a[164:167], v[32:35], v[200:203]
    buffer_load_dwordx4 v24, s[36:39], s51 offen offset:1024 lds
    ds_read_b64_tr_b16 a[178:179], v12 offset:1024
    v_mfma_f32_16x16x32_bf16 v[220:223], a[168:171], v[32:35], v[220:223]
    v_exp_f32 v55, v55
    v_mfma_f32_16x16x32_bf16 v[240:243], a[172:175], v[32:35], v[240:243]
    ds_read_b64_tr_b16 a[180:181], v13 offset:0
    v_cvt_pk_bf16_f32 v31, v54, v55
    v_mfma_f32_16x16x32_bf16 a[212:215], a[248:251], v[32:35], a[212:215]
    ds_read_b64_tr_b16 a[182:183], v13 offset:1024
    ds_read_b64_tr_b16 a[184:185], v14 offset:0
    v_mfma_f32_16x16x32_bf16 v[48:51], a[112:115], a[32:35], v[72:75]
    v_exp_f32 v56, v56
    v_mfma_f32_16x16x32_bf16 v[48:51], a[116:119], a[36:39], v[48:51]
    buffer_load_dwordx4 v25, s[36:39], s51 offen offset:2048 lds
    ds_read_b64_tr_b16 a[186:187], v14 offset:1024
    v_mfma_f32_16x16x32_bf16 v[48:51], a[120:123], a[40:43], v[48:51]
    v_exp_f32 v57, v57
    v_mfma_f32_16x16x32_bf16 v[48:51], a[124:127], a[44:47], v[48:51]
    ds_read_b64_tr_b16 a[188:189], v15 offset:0
    v_cvt_pk_bf16_f32 v32, v56, v57
    v_mfma_f32_16x16x32_bf16 v[52:55], a[128:131], a[32:35], v[72:75]
    v_exp_f32 v58, v58
    v_mfma_f32_16x16x32_bf16 v[52:55], a[132:135], a[36:39], v[52:55]
    buffer_load_dwordx4 v25, s[36:39], s51 offen offset:3072 lds
    ds_read_b64_tr_b16 a[190:191], v15 offset:1024
    v_mfma_f32_16x16x32_bf16 v[52:55], a[136:139], a[40:43], v[52:55]
    v_exp_f32 v59, v59
    v_mfma_f32_16x16x32_bf16 v[52:55], a[140:143], a[44:47], v[52:55]
    s_add_u32 m0, s52, 86016
    s_and_b32 s50, s90, 0xe000
    v_cvt_pk_bf16_f32 v33, v58, v59
    v_mfma_f32_16x16x32_bf16 v[104:107], a[144:147], v[36:39], v[104:107]
    v_exp_f32 v60, v60
    v_mfma_f32_16x16x32_bf16 v[124:127], a[148:151], v[36:39], v[124:127]
    ds_read_b64_tr_b16 a[192:193], v16 offset:0
    ds_read_b64_tr_b16 a[194:195], v16 offset:1024
    v_mfma_f32_16x16x32_bf16 v[144:147], a[152:155], v[36:39], v[144:147]
    v_exp_f32 v61, v61
    v_mfma_f32_16x16x32_bf16 v[164:167], a[156:159], v[36:39], v[164:167]
    buffer_load_dwordx4 v20, s[32:35], s48 offen offset:0 lds
    s_or_b32 s51, s50, 4096
    v_cvt_pk_bf16_f32 v34, v60, v61
    v_mfma_f32_16x16x32_bf16 v[184:187], a[160:163], v[36:39], v[184:187]
    v_exp_f32 v62, v62
    v_mfma_f32_16x16x32_bf16 v[204:207], a[164:167], v[36:39], v[204:207]
    ds_read_b64_tr_b16 a[196:197], v17 offset:0
    ds_read_b64_tr_b16 a[198:199], v17 offset:1024
    v_mfma_f32_16x16x32_bf16 v[224:227], a[168:171], v[36:39], v[224:227]
    v_exp_f32 v63, v63
    v_mfma_f32_16x16x32_bf16 v[244:247], a[172:175], v[36:39], v[244:247]
    buffer_load_dwordx4 v20, s[32:35], s48 offen offset:1024 lds
    v_cvt_pk_bf16_f32 v35, v62, v63
    v_mfma_f32_16x16x32_bf16 a[216:219], a[248:251], v[36:39], a[216:219]
    ds_read_b64_tr_b16 a[200:201], v18 offset:0
    ds_read_b64_tr_b16 a[202:203], v18 offset:1024
    v_mfma_f32_16x16x32_bf16 v[56:59], a[112:115], a[48:51], v[76:79]
    v_exp_f32 v48, v48
    v_mfma_f32_16x16x32_bf16 v[56:59], a[116:119], a[52:55], v[56:59]
    ds_read_b64_tr_b16 a[204:205], v19 offset:0
    ds_read_b64_tr_b16 a[206:207], v19 offset:1024
    v_mfma_f32_16x16x32_bf16 v[56:59], a[120:123], a[56:59], v[56:59]
    v_exp_f32 v49, v49
    v_mfma_f32_16x16x32_bf16 v[56:59], a[124:127], a[60:63], v[56:59]
    buffer_load_dwordx4 v21, s[32:35], s48 offen offset:2048 lds
    v_cvt_pk_bf16_f32 v36, v48, v49
    v_mfma_f32_16x16x32_bf16 v[60:63], a[128:131], a[48:51], v[76:79]
    v_exp_f32 v50, v50
    v_mfma_f32_16x16x32_bf16 v[60:63], a[132:135], a[52:55], v[60:63]
    s_waitcnt vmcnt(11)
    ds_read_b128 a[80:83], v8 offset:0
    v_mfma_f32_16x16x32_bf16 v[60:63], a[136:139], a[56:59], v[60:63]
    v_exp_f32 v51, v51
    v_mfma_f32_16x16x32_bf16 v[60:63], a[140:143], a[60:63], v[60:63]
    buffer_load_dwordx4 v21, s[32:35], s48 offen offset:3072 lds
    v_cvt_pk_bf16_f32 v37, v50, v51
    v_mfma_f32_16x16x32_bf16 v[108:111], a[144:147], v[40:43], v[108:111]
    v_exp_f32 v52, v52
    v_mfma_f32_16x16x32_bf16 v[128:131], a[148:151], v[40:43], v[128:131]
    s_add_u32 m0, s52, 90112
    ds_read_b128 a[84:87], v9 offset:0
    v_mfma_f32_16x16x32_bf16 v[148:151], a[152:155], v[40:43], v[148:151]
    v_exp_f32 v53, v53
    v_mfma_f32_16x16x32_bf16 v[168:171], a[156:159], v[40:43], v[168:171]
    ds_read_b128 a[88:91], v10 offset:0
    v_cvt_pk_bf16_f32 v38, v52, v53
    v_mfma_f32_16x16x32_bf16 v[188:191], a[160:163], v[40:43], v[188:191]
    v_exp_f32 v54, v54
    v_mfma_f32_16x16x32_bf16 v[208:211], a[164:167], v[40:43], v[208:211]
    buffer_load_dwordx4 v22, s[32:35], s49 offen offset:0 lds
    ds_read_b128 a[92:95], v11 offset:0
    v_mfma_f32_16x16x32_bf16 v[228:231], a[168:171], v[40:43], v[228:231]
    v_exp_f32 v55, v55
    v_mfma_f32_16x16x32_bf16 v[248:251], a[172:175], v[40:43], v[248:251]
    ds_read_b128 a[96:99], v8 offset:1024
    v_cvt_pk_bf16_f32 v39, v54, v55
    v_mfma_f32_16x16x32_bf16 a[220:223], a[248:251], v[40:43], a[220:223]
    ds_read_b128 a[100:103], v9 offset:1024
    ds_read_b128 a[104:107], v10 offset:1024
    v_mfma_f32_16x16x32_bf16 v[48:51], a[112:115], a[64:67], v[80:83]
    v_exp_f32 v56, v56
    v_mfma_f32_16x16x32_bf16 v[48:51], a[116:119], a[68:71], v[48:51]
    buffer_load_dwordx4 v22, s[32:35], s49 offen offset:1024 lds
    ds_read_b128 a[108:111], v11 offset:1024
    v_mfma_f32_16x16x32_bf16 v[48:51], a[120:123], a[72:75], v[48:51]
    v_exp_f32 v57, v57
    v_mfma_f32_16x16x32_bf16 v[48:51], a[124:127], a[76:79], v[48:51]
    s_and_b32 s48, s93, 0xe000
    v_cvt_pk_bf16_f32 v40, v56, v57
    v_mfma_f32_16x16x32_bf16 v[52:55], a[128:131], a[64:67], v[80:83]
    v_exp_f32 v58, v58
    v_mfma_f32_16x16x32_bf16 v[52:55], a[132:135], a[68:71], v[52:55]
    buffer_load_dwordx4 v23, s[32:35], s49 offen offset:2048 lds
    v_mfma_f32_16x16x32_bf16 v[52:55], a[136:139], a[72:75], v[52:55]
    v_exp_f32 v59, v59
    v_mfma_f32_16x16x32_bf16 v[52:55], a[140:143], a[76:79], v[52:55]
    v_cvt_pk_bf16_f32 v41, v58, v59
    v_mfma_f32_16x16x32_bf16 v[112:115], a[144:147], v[44:47], v[112:115]
    v_exp_f32 v60, v60
    v_mfma_f32_16x16x32_bf16 v[132:135], a[148:151], v[44:47], v[132:135]
    buffer_load_dwordx4 v23, s[32:35], s49 offen offset:3072 lds
    v_mfma_f32_16x16x32_bf16 v[152:155], a[152:155], v[44:47], v[152:155]
    v_exp_f32 v61, v61
    v_mfma_f32_16x16x32_bf16 v[172:175], a[156:159], v[44:47], v[172:175]
    s_add_u32 s53, s53, 1
    v_cvt_pk_bf16_f32 v42, v60, v61
    v_mfma_f32_16x16x32_bf16 v[192:195], a[160:163], v[44:47], v[192:195]
    v_exp_f32 v62, v62
    v_mfma_f32_16x16x32_bf16 v[212:215], a[164:167], v[44:47], v[212:215]
    s_or_b32 s49, s48, 4096
    v_mfma_f32_16x16x32_bf16 v[232:235], a[168:171], v[44:47], v[232:235]
    v_exp_f32 v63, v63
    v_mfma_f32_16x16x32_bf16 v[252:255], a[172:175], v[44:47], v[252:255]
    s_waitcnt lgkmcnt(0)
    v_cvt_pk_bf16_f32 v43, v62, v63
    v_mfma_f32_16x16x32_bf16 a[224:227], a[248:251], v[44:47], a[224:227]
    s_cmp_eq_u32 s53, 3
    s_cbranch_scc1 L_exit
    s_cmp_eq_u32 s53, 2
    s_cbranch_scc1 L_hook
L_back:
    v_mfma_f32_16x16x32_bf16 v[56:59], a[80:83], a[0:3], v[64:67]
    v_exp_f32 v48, v48
    v_mfma_f32_16x16x32_bf16 v[56:59], a[84:87], a[4:7], v[56:59]
    s_lshr_b32 s93, s93, 3
    v_mfma_f32_16x16x32_bf16 v[56:59], a[88:91], a[8:11], v[56:59]
    v_exp_f32 v49, v49
    v_mfma_f32_16x16x32_bf16 v[56:59], a[92:95], a[12:15], v[56:59]
    v_cvt_pk_bf16_f32 v44, v48, v49
    v_mfma_f32_16x16x32_bf16 v[60:63], a[96:99], a[0:3], v[64:67]
    v_exp_f32 v50, v50
    v_mfma_f32_16x16x32_bf16 v[60:63], a[100:103], a[4:7], v[60:63]
    s_add_u32 m0, s52, 0
    v_mfma_f32_16x16x32_bf16 v[60:63], a[104:107], a[8:11], v[60:63]
    v_exp_f32 v51, v51
    v_mfma_f32_16x16x32_bf16 v[60:63], a[108:111], a[12:15], v[60:63]
    v_cvt_pk_bf16_f32 v45, v50, v51
    v_mfma_f32_16x16x32_bf16 v[96:99], a[176:179], v[28:31], v[96:99]
    v_exp_f32 v52, v52
    v_mfma_f32_16x16x32_bf16 v[116:119], a[180:183], v[28:31], v[116:119]
    buffer_load_dwordx4 v24, s[36:39], s50 offen offset:0 lds
    v_mfma_f32_16x16x32_bf16 v[136:139], a[184:187], v[28:31], v[136:139]
    v_exp_f32 v53, v53
    v_mfma_f32_16x16x32_bf16 v[156:159], a[188:191], v[28:31], v[156:159]
    v_cvt_pk_bf16_f32 v46, v52, v53
    v_mfma_f32_16x16x32_bf16 v[176:179], a[192:195], v[28:31], v[176:179]
    v_exp_f32 v54, v54
    v_mfma_f32_16x16x32_bf16 v[196:199], a[196:199], v[28:31], v[196:199]
    buffer_load_dwordx4 v24, s[36:39], s50 offen offset:1024 lds
    v_mfma_f32_16x16x32_bf16 v[216:219], a[200:203], v[28:31], v[216:219]
    v_exp_f32 v55, v55
    v_mfma_f32_16x16x32_bf16 v[236:239], a[204:207], v[28:31], v[236:239]
    v_cvt_pk_bf16_f32 v47, v54, v55
    v_mfma_f32_16x16x32_bf16 a[208:211], a[248:251], v[28:31], a[208:211]
    s_lshr_b32 s90, s90, 3
    v_mfma_f32_16x16x32_bf16 v[48:51], a[80:83], a[16:19], v[68:71]
    v_exp_f32 v56, v56
    v_mfma_f32_16x16x32_bf16 v[48:51], a[84:87], a[20:23], v[48:51]
    buffer_load_dwordx4 v25, s[36:39], s50 offen offset:2048 lds
    v_mfma_f32_16x16x32_bf16 v[48:51], a[88:91], a[24:27], v[48:51]
    v_exp_f32 v57, v57
    v_mfma_f32_16x16x32_bf16 v[48:51], a[92:95], a[28:31], v[48:51]
    v_cvt_pk_bf16_f32 v28, v56, v57
    v_mfma_f32_16x16x32_bf16 v[52:55], a[96:99], a[16:19], v[68:71]
    v_exp_f32 v58, v58
    v_mfma_f32_16x16x32_bf16 v[52:55], a[100:103], a[20:23], v[52:55]
    buffer_load_dwordx4 v25, s[36:39], s50 offen offset:3072 lds
    v_mfma_f32_16x16x32_bf16 v[52:55], a[104:107], a[24:27], v[52:55]
    v_exp_f32 v59, v59
    v_mfma_f32_16x16x32_bf16 v[52:55], a[108:111], a[28:31], v[52:55]
    s_add_u32 m0, s52, 4096
    v_cvt_pk_bf16_f32 v29, v58, v59
    v_mfma_f32_16x16x32_bf16 v[100:103], a[176:179], v[32:35], v[100:103]
    v_exp_f32 v60, v60
    v_mfma_f32_16x16x32_bf16 v[120:123], a[180:183], v[32:35], v[120:123]
    buffer_load_dwordx4 v24, s[36:39], s51 offen offset:0 lds
    v_mfma_f32_16x16x32_bf16 v[140:143], a[184:187], v[32:35], v[140:143]
    v_exp_f32 v61, v61
    v_mfma_f32_16x16x32_bf16 v[160:163], a[188:191], v[32:35], v[160:163]
    s_waitcnt vmcnt(13)
    ds_read_b64_tr_b16 a[144:145], v84 offset:0
    v_cvt_pk_bf16_f32 v30, v60, v61
    v_mfma_f32_16x16x32_bf16 v[180:183], a[192:195], v[32:35], v[180:183]
    v_exp_f32 v62, v62
    v_mfma_f32_16x16x32_bf16 v[200:203], a[196:199], v[32:35], v[200:203]
    buffer_load_dwordx4 v24, s[36:39], s51 offen offset:1024 lds
    ds_read_b64_tr_b16 a[146:147], v84 offset:1024
    v_mfma_f32_16x16x32_bf16 v[220:223], a[200:203], v[32:35], v[220:223]
    v_exp_f32 v63, v63
    v_mfma_f32_16x16x32_bf16 v[240:243], a[204:207], v[32:35], v[240:243]
    ds_read_b64_tr_b16 a[148:149], v85 offset:0
    v_cvt_pk_bf16_f32 v31, v62, v63
    v_mfma_f32_16x16x32_bf16 a[212:215], a[248:251], v[32:35], a[212:215]
    ds_read_b64_tr_b16 a[150:151], v85 offset:1024
    ds_read_b64_tr_b16 a[152:153], v86 offset:0
    v_mfma_f32_16x16x32_bf16 v[56:59], a[80:83], a[32:35], v[72:75]
    v_exp_f32 v48, v48
    v_mfma_f32_16x16x32_bf16 v[56:59], a[84:87], a[36:39], v[56:59]
    buffer_load_dwordx4 v25, s[36:39], s51 offen offset:2048 lds
    ds_read_b64_tr_b16 a[154:155], v86 offset:1024
    v_mfma_f32_16x16x32_bf16 v[56:59], a[88:91], a[40:43], v[56:59]
    v_exp_f32 v49, v49
    v_mfma_f32_16x16x32_bf16 v[56:59], a[92:95], a[44:47], v[56:59]
    ds_read_b64_tr_b16 a[156:157], v87 offset:0
    v_cvt_pk_bf16_f32 v32, v48, v49
    v_mfma_f32_16x16x32_bf16 v[60:63], a[96:99], a[32:35], v[72:75]
    v_exp_f32 v50, v50
    v_mfma_f32_16x16x32_bf16 v[60:63], a[100:103], a[36:39], v[60:63]
    buffer_load_dwordx4 v25, s[36:39], s51 offen offset:3072 lds
    ds_read_b64_tr_b16 a[158:159], v87 offset:1024
    v_mfma_f32_16x16x32_bf16 v[60:63], a[104:107], a[40:43], v[60:63]
    v_exp_f32 v51, v51
    v_mfma_f32_16x16x32_bf16 v[60:63], a[108:111], a[44:47], v[60:63]
    s_add_u32 m0, s52, 53248
    s_and_b32 s50, s90, 0xe000
    v_cvt_pk_bf16_f32 v33, v50, v51
    v_mfma_f32_16x16x32_bf16 v[104:107], a[176:179], v[36:39], v[104:107]
    v_exp_f32 v52, v52
    v_mfma_f32_16x16x32_bf16 v[124:127], a[180:183], v[36:39], v[124:127]
    ds_read_b64_tr_b16 a[160:161], v88 offset:0
    ds_read_b64_tr_b16 a[162:163], v88 offset:1024
    v_mfma_f32_16x16x32_bf16 v[144:147], a[184:187], v[36:39], v[144:147]
    v_exp_f32 v53, v53
    v_mfma_f32_16x16x32_bf16 v[164:167], a[188:191], v[36:39], v[164:167]
    buffer_load_dwordx4 v20, s[32:35], s48 offen offset:0 lds
    s_or_b32 s51, s50, 4096
    v_cvt_pk_bf16_f32 v34, v52, v53
    v_mfma_f32_16x16x32_bf16 v[184:187], a[192:195], v[36:39], v[184:187]
    v_exp_f32 v54, v54
    v_mfma_f32_16x16x32_bf16 v[204:207], a[196:199], v[36:39], v[204:207]
    ds_read_b64_tr_b16 a[164:165], v89 offset:0
    ds_read_b64_tr_b16 a[166:167], v89 offset:1024
    v_mfma_f32_16x16x32_bf16 v[224:227], a[200:203], v[36:39], v[224:227]
    v_exp_f32 v55, v55
    v_mfma_f32_16x16x32_bf16 v[244:247], a[204:207], v[36:39], v[244:247]
    buffer_load_dwordx4 v20, s[32:35], s48 offen offset:1024 lds
    v_cvt_pk_bf16_f32 v35, v54, v55
    v_mfma_f32_16x16x32_bf16 a[216:219], a[248:251], v[36:39], a[216:219]
    ds_read_b64_tr_b16 a[168:169], v90 offset:0
    ds_read_b64_tr_b16 a[170:171], v90 offset:1024
    v_mfma_f32_16x16x32_bf16 v[48:51], a[80:83], a[48:51], v[76:79]
    v_exp_f32 v56, v56
    v_mfma_f32_16x16x32_bf16 v[48:51], a[84:87], a[52:55], v[48:51]
    ds_read_b64_tr_b16 a[172:173], v91 offset:0
    ds_read_b64_tr_b16 a[174:175], v91 offset:1024
    v_mfma_f32_16x16x32_bf16 v[48:51], a[88:91], a[56:59], v[48:51]
    v_exp_f32 v57, v57
    v_mfma_f32_16x16x32_bf16 v[48:51], a[92:95], a[60:63], v[48:51]
    buffer_load_dwordx4 v21, s[32:35], s48 offen offset:2048 lds
    v_cvt_pk_bf16_f32 v36, v56, v57
    v_mfma_f32_16x16x32_bf16 v[52:55], a[96:99], a[48:51], v[76:79]
    v_exp_f32 v58, v58
    v_mfma_f32_16x16x32_bf16 v[52:55], a[100:103], a[52:55], v[52:55]
    s_waitcnt vmcnt(11)
    ds_read_b128 a[112:115], v8 offset:32768
    v_mfma_f32_16x16x32_bf16 v[52:55], a[104:107], a[56:59], v[52:55]
    v_exp_f32 v59, v59
    v_mfma_f32_16x16x32_bf16 v[52:55], a[108:111], a[60:63], v[52:55]
    buffer_load_dwordx4 v21, s[32:35], s48 offen offset:3072 lds
    v_cvt_pk_bf16_f32 v37, v58, v59
    v_mfma_f32_16x16x32_bf16 v[108:111], a[176:179], v[40:43], v[108:111]
    v_exp_f32 v60, v60
    v_mfma_f32_16x16x32_bf16 v[128:131], a[180:183], v[40:43], v[128:131]
    s_add_u32 m0, s52, 57344
    ds_read_b128 a[116:119], v9 offset:32768
    v_mfma_f32_16x16x32_bf16 v[148:151], a[184:187], v[40:43], v[148:151]
    v_exp_f32 v61, v61
    v_mfma_f32_16x16x32_bf16 v[168:171], a[188:191], v[40:43], v[168:171]
    ds_read_b128 a[120:123], v10 offset:32768
    v_cvt_pk_bf16_f32 v38, v60, v61
    v_mfma_f32_16x16x32_bf16 v[188:191], a[192:195], v[40:43], v[188:191]
    v_exp_f32 v62, v62
    v_mfma_f32_16x16x32_bf16 v[208:211], a[196:199], v[40:43], v[208:211]
    buffer_load_dwordx4 v22, s[32:35], s49 offen offset:0 lds
    ds_read_b128 a[124:127], v11 offset:32768
    v_mfma_f32_16x16x32_bf16 v[228:231], a[200:203], v[40:43], v[228:231]
    v_exp_f32 v63, v63
    v_mfma_f32_16x16x32_bf16 v[248:251], a[204:207], v[40:43], v[248:251]
    ds_read_b128 a[128:131], v8 offset:33792
    v_cvt_pk_bf16_f32 v39, v62, v63
    v_mfma_f32_16x16x32_bf16 a[220:223], a[248:251], v[40:43], a[220:223]
    ds_read_b128 a[132:135], v9 offset:33792
    ds_read_b128 a[136:139], v10 offset:33792
    v_mfma_f32_16x16x32_bf16 v[56:59], a[80:83], a[64:67], v[80:83]
    v_exp_f32 v48, v48
    v_mfma_f32_16x16x32_bf16 v[56:59], a[84:87], a[68:71], v[56:59]
    buffer_load_dwordx4 v22, s[32:35], s49 offen offset:1024 lds
    ds_read_b128 a[140:143], v11 offset:33792
    v_mfma_f32_16x16x32_bf16 v[56:59], a[88:91], a[72:75], v[56:59]
    v_exp_f32 v49, v49
    v_mfma_f32_16x16x32_bf16 v[56:59], a[92:95], a[76:79], v[56:59]
    s_and_b32 s48, s93, 0xe000
    v_cvt_pk_bf16_f32 v40, v48, v49
    v_mfma_f32_16x16x32_bf16 v[60:63], a[96:99], a[64:67], v[80:83]
    v_exp_f32 v50, v50
    v_mfma_f32_16x16x32_bf16 v[60:63], a[100:103], a[68:71], v[60:63]
    buffer_load_dwordx4 v23, s[32:35], s49 offen offset:2048 lds
    v_mfma_f32_16x16x32_bf16 v[60:63], a[104:107], a[72:75], v[60:63]
    v_exp_f32 v51, v51
    v_mfma_f32_16x16x32_bf16 v[60:63], a[108:111], a[76:79], v[60:63]
    v_cvt_pk_bf16_f32 v41, v50, v51
    v_mfma_f32_16x16x32_bf16 v[112:115], a[176:179], v[44:47], v[112:115]
    v_exp_f32 v52, v52
    v_mfma_f32_16x16x32_bf16 v[132:135], a[180:183], v[44:47], v[132:135]
    buffer_load_dwordx4 v23, s[32:35], s49 offen offset:3072 lds
    v_mfma_f32_16x16x32_bf16 v[152:155], a[184:187], v[44:47], v[152:155]
    v_exp_f32 v53, v53
    v_mfma_f32_16x16x32_bf16 v[172:175], a[188:191], v[44:47], v[172:175]
    v_cvt_pk_bf16_f32 v42, v52, v53
    v_mfma_f32_16x16x32_bf16 v[192:195], a[192:195], v[44:47], v[192:195]
    v_exp_f32 v54, v54
    v_mfma_f32_16x16x32_bf16 v[212:215], a[196:199], v[44:47], v[212:215]
    s_or_b32 s49, s48, 4096
    v_mfma_f32_16x16x32_bf16 v[232:235], a[200:203], v[44:47], v[232:235]
    v_exp_f32 v55, v55
    v_mfma_f32_16x16x32_bf16 v[252:255], a[204:207], v[44:47], v[252:255]
    s_waitcnt lgkmcnt(0)
    v_cvt_pk_bf16_f32 v43, v54, v55
    v_mfma_f32_16x16x32_bf16 a[224:227], a[248:251], v[44:47], a[224:227]
    s_branch L_loop
L_hook:
    s_lshl_b32 s58, s21, 2
    s_add_u32 s58, s58, s22
    s_lshl_b32 s58, s58, 2
    s_add_u32 s58, s58, s3
    s_lshl_b32 s58, s58, 12
    s_lshl_b32 s59, s22, 8
    s_sub_u32 s58, s58, s59
    v_add_u32 v2, s58, v3
    s_mov_b32 exec_hi, 0
    buffer_load_dword v1, v2, s[44:47], 0 offen
    s_mov_b32 exec_hi, -1
    s_getpc_b64 s[58:59]
L_pc1:
    s_lshr_b32 s57, s2, 3
    s_lshl_b32 s57, s57, 2
    s_add_u32 s57, s57, s3
    s_lshl_b32 s57, s57, 7
    s_min_u32 s57, s57, L_end-L_pc1-4
    v_mov_b32 v2, s57
    s_mov_b64 exec, 1
    global_load_dword v1, v2, s[58:59]
    s_mov_b64 exec, -1
    s_branch L_back
L_exit:
    v_mov_b32 v1, 0
    buffer_load_dword v27, v1, s[28:31], s55 offen sc1
    v_mfma_f32_16x16x32_bf16 v[56:59], a[80:83], a[0:3], v[64:67]
    v_exp_f32 v48, v48
    v_mfma_f32_16x16x32_bf16 v[56:59], a[84:87], a[4:7], v[56:59]
    s_add_u32 s48, s60, 4096
    s_mov_b32 s49, 5120
    s_mov_b32 s24, s18
    s_add_u32 m0, s52, 0
    s_nop 0
    buffer_load_dwordx4 v24, s[36:39], s50 offen offset:0 lds
    v_mfma_f32_16x16x32_bf16 v[56:59], a[88:91], a[8:11], v[56:59]
    v_exp_f32 v49, v49
    v_mfma_f32_16x16x32_bf16 v[56:59], a[92:95], a[12:15], v[56:59]
    s_mov_b32 s25, s19
    v_cvt_pk_bf16_f32 v44, v48, v49
    s_mov_b32 s26, 16842752
    buffer_load_dwordx4 v24, s[36:39], s50 offen offset:1024 lds
    v_mfma_f32_16x16x32_bf16 v[60:63], a[96:99], a[0:3], v[64:67]
    v_exp_f32 v50, v50
    v_mfma_f32_16x16x32_bf16 v[60:63], a[100:103], a[4:7], v[60:63]
    s_mov_b32 s27, 0x20000
    s_mov_b32 s62, 0
    buffer_load_dwordx4 v25, s[36:39], s50 offen offset:2048 lds
    v_mfma_f32_16x16x32_bf16 v[60:63], a[104:107], a[8:11], v[60:63]
    v_exp_f32 v51, v51
    v_mfma_f32_16x16x32_bf16 v[60:63], a[108:111], a[12:15], v[60:63]
    buffer_load_dwordx4 v25, s[36:39], s50 offen offset:3072 lds
    v_cvt_pk_bf16_f32 v45, v50, v51
    v_mfma_f32_16x16x32_bf16 v[96:99], a[176:179], v[28:31], v[96:99]
    v_exp_f32 v52, v52
    v_mfma_f32_16x16x32_bf16 v[116:119], a[180:183], v[28:31], v[116:119]
    s_add_u32 m0, s52, 4096
    v_mfma_f32_16x16x32_bf16 v[136:139], a[184:187], v[28:31], v[136:139]
    v_exp_f32 v53, v53
    v_mfma_f32_16x16x32_bf16 v[156:159], a[188:191], v[28:31], v[156:159]
    buffer_load_dwordx4 v24, s[36:39], s51 offen offset:0 lds
    v_cvt_pk_bf16_f32 v46, v52, v53
    buffer_load_dwordx4 v24, s[36:39], s51 offen offset:1024 lds
    v_mfma_f32_16x16x32_bf16 v[176:179], a[192:195], v[28:31], v[176:179]
    v_exp_f32 v54, v54
    v_mfma_f32_16x16x32_bf16 v[196:199], a[196:199], v[28:31], v[196:199]
    buffer_load_dwordx4 v25, s[36:39], s51 offen offset:2048 lds
    v_mfma_f32_16x16x32_bf16 v[216:219], a[200:203], v[28:31], v[216:219]
    v_exp_f32 v55, v55
    v_mfma_f32_16x16x32_bf16 v[236:239], a[204:207], v[28:31], v[236:239]
    buffer_load_dwordx4 v25, s[36:39], s51 offen offset:3072 lds
    v_cvt_pk_bf16_f32 v47, v54, v55
    v_mfma_f32_16x16x32_bf16 a[208:211], a[248:251], v[28:31], a[208:211]
    v_mfma_f32_16x16x32_bf16 v[48:51], a[80:83], a[16:19], v[68:71]
    v_exp_f32 v56, v56
    v_mfma_f32_16x16x32_bf16 v[48:51], a[84:87], a[20:23], v[48:51]
    v_mfma_f32_16x16x32_bf16 v[48:51], a[88:91], a[24:27], v[48:51]
    v_exp_f32 v57, v57
    v_mfma_f32_16x16x32_bf16 v[48:51], a[92:95], a[28:31], v[48:51]
    v_cvt_pk_bf16_f32 v28, v56, v57
    v_mfma_f32_16x16x32_bf16 v[52:55], a[96:99], a[16:19], v[68:71]
    v_exp_f32 v58, v58
    v_mfma_f32_16x16x32_bf16 v[52:55], a[100:103], a[20:23], v[52:55]
    v_mfma_f32_16x16x32_bf16 v[52:55], a[104:107], a[24:27], v[52:55]
    v_exp_f32 v59, v59
    v_mfma_f32_16x16x32_bf16 v[52:55], a[108:111], a[28:31], v[52:55]
    v_cvt_pk_bf16_f32 v29, v58, v59
    buffer_store_dwordx4 v[92:95], v26, s[40:43], s60 offen offset:0 sc1
    v_mfma_f32_16x16x32_bf16 v[100:103], a[176:179], v[32:35], v[100:103]
    v_exp_f32 v60, v60
    v_mfma_f32_16x16x32_bf16 v[120:123], a[180:183], v[32:35], v[120:123]
    v_mfma_f32_16x16x32_bf16 v[140:143], a[184:187], v[32:35], v[140:143]
    v_exp_f32 v61, v61
    v_mfma_f32_16x16x32_bf16 v[160:163], a[188:191], v[32:35], v[160:163]
    s_waitcnt vmcnt(18)
    v_cvt_pk_bf16_f32 v30, v60, v61
    ds_read_b64_tr_b16 a[144:145], v84 offset:0
    v_mfma_f32_16x16x32_bf16 v[180:183], a[192:195], v[32:35], v[180:183]
    v_exp_f32 v62, v62
    v_mfma_f32_16x16x32_bf16 v[200:203], a[196:199], v[32:35], v[200:203]
    ds_read_b64_tr_b16 a[146:147], v84 offset:1024
    s_mov_b32 s51, 9216
    v_mfma_f32_16x16x32_bf16 v[220:223], a[200:203], v[32:35], v[220:223]
    v_exp_f32 v63, v63
    v_mfma_f32_16x16x32_bf16 v[240:243], a[204:207], v[32:35], v[240:243]
    ds_read_b64_tr_b16 a[148:149], v85 offset:0
    v_cvt_pk_bf16_f32 v31, v62, v63
    buffer_store_dwordx4 v[92:95], v26, s[40:43], s60 offen offset:1024 sc1
    v_mfma_f32_16x16x32_bf16 a[212:215], a[248:251], v[32:35], a[212:215]
    ds_read_b64_tr_b16 a[150:151], v85 offset:1024
    ds_read_b64_tr_b16 a[152:153], v86 offset:0
    v_mfma_f32_16x16x32_bf16 v[56:59], a[80:83], a[32:35], v[72:75]
    v_exp_f32 v48, v48
    v_mfma_f32_16x16x32_bf16 v[56:59], a[84:87], a[36:39], v[56:59]
    ds_read_b64_tr_b16 a[154:155], v86 offset:1024
    v_mfma_f32_16x16x32_bf16 v[56:59], a[88:91], a[40:43], v[56:59]
    v_exp_f32 v49, v49
    v_mfma_f32_16x16x32_bf16 v[56:59], a[92:95], a[44:47], v[56:59]
    ds_read_b64_tr_b16 a[156:157], v87 offset:0
    v_cvt_pk_bf16_f32 v32, v48, v49
    v_mfma_f32_16x16x32_bf16 v[60:63], a[96:99], a[32:35], v[72:75]
    v_exp_f32 v50, v50
    v_mfma_f32_16x16x32_bf16 v[60:63], a[100:103], a[36:39], v[60:63]
    ds_read_b64_tr_b16 a[158:159], v87 offset:1024
    v_mfma_f32_16x16x32_bf16 v[60:63], a[104:107], a[40:43], v[60:63]
    v_exp_f32 v51, v51
    v_mfma_f32_16x16x32_bf16 v[60:63], a[108:111], a[44:47], v[60:63]
    v_cvt_pk_bf16_f32 v33, v50, v51
    buffer_store_dwordx4 v[92:95], v26, s[40:43], s60 offen offset:2048 sc1
    v_mfma_f32_16x16x32_bf16 v[104:107], a[176:179], v[36:39], v[104:107]
    v_exp_f32 v52, v52
    v_mfma_f32_16x16x32_bf16 v[124:127], a[180:183], v[36:39], v[124:127]
    ds_read_b64_tr_b16 a[160:161], v88 offset:0
    ds_read_b64_tr_b16 a[162:163], v88 offset:1024
    v_mfma_f32_16x16x32_bf16 v[144:147], a[184:187], v[36:39], v[144:147]
    v_exp_f32 v53, v53
    v_mfma_f32_16x16x32_bf16 v[164:167], a[188:191], v[36:39], v[164:167]
    v_cvt_pk_bf16_f32 v34, v52, v53
    v_mfma_f32_16x16x32_bf16 v[184:187], a[192:195], v[36:39], v[184:187]
    v_exp_f32 v54, v54
    v_mfma_f32_16x16x32_bf16 v[204:207], a[196:199], v[36:39], v[204:207]
    ds_read_b64_tr_b16 a[164:165], v89 offset:0
    ds_read_b64_tr_b16 a[166:167], v89 offset:1024
    v_mfma_f32_16x16x32_bf16 v[224:227], a[200:203], v[36:39], v[224:227]
    v_exp_f32 v55, v55
    v_mfma_f32_16x16x32_bf16 v[244:247], a[204:207], v[36:39], v[244:247]
    v_cvt_pk_bf16_f32 v35, v54, v55
    buffer_store_dwordx4 v[92:95], v26, s[40:43], s60 offen offset:3072 sc1
    v_mfma_f32_16x16x32_bf16 a[216:219], a[248:251], v[36:39], a[216:219]
    ds_read_b64_tr_b16 a[168:169], v90 offset:0
    ds_read_b64_tr_b16 a[170:171], v90 offset:1024
    v_mfma_f32_16x16x32_bf16 v[48:51], a[80:83], a[48:51], v[76:79]
    v_exp_f32 v56, v56
    v_mfma_f32_16x16x32_bf16 v[48:51], a[84:87], a[52:55], v[48:51]
    ds_read_b64_tr_b16 a[172:173], v91 offset:0
    ds_read_b64_tr_b16 a[174:175], v91 offset:1024
    v_mfma_f32_16x16x32_bf16 v[48:51], a[88:91], a[56:59], v[48:51]
    v_exp_f32 v57, v57
    v_mfma_f32_16x16x32_bf16 v[48:51], a[92:95], a[60:63], v[48:51]
    v_cvt_pk_bf16_f32 v36, v56, v57
    v_mfma_f32_16x16x32_bf16 v[52:55], a[96:99], a[48:51], v[76:79]
    v_exp_f32 v58, v58
    v_mfma_f32_16x16x32_bf16 v[52:55], a[100:103], a[52:55], v[52:55]
    s_waitcnt vmcnt(13)
    ds_read_b128 a[112:115], v8 offset:32768
    buffer_store_dwordx4 v[92:95], v26, s[40:43], s48 offen sc1
    v_mfma_f32_16x16x32_bf16 v[52:55], a[104:107], a[56:59], v[52:55]
    v_exp_f32 v59, v59
    v_mfma_f32_16x16x32_bf16 v[52:55], a[108:111], a[60:63], v[52:55]
    s_waitcnt vmcnt(13)
    v_cvt_pk_bf16_f32 v37, v58, v59
    v_readfirstlane_b32 s58, v27
    v_accvgpr_read_b32 v20, a241
    v_accvgpr_read_b32 v21, a242
    v_accvgpr_read_b32 v22, a243
    v_accvgpr_read_b32 v23, a244
    v_mfma_f32_16x16x32_bf16 v[108:111], a[176:179], v[40:43], v[108:111]
    v_exp_f32 v60, v60
    v_mfma_f32_16x16x32_bf16 v[128:131], a[180:183], v[40:43], v[128:131]
    ds_read_b128 a[116:119], v9 offset:32768
    s_cmp_ge_u32 s58, 32
    s_cbranch_scc0 L_hs
L_hsok:
    v_mfma_f32_16x16x32_bf16 v[148:151], a[184:187], v[40:43], v[148:151]
    v_exp_f32 v61, v61
    v_mfma_f32_16x16x32_bf16 v[168:171], a[188:191], v[40:43], v[168:171]
    ds_read_b128 a[120:123], v10 offset:32768
    v_cvt_pk_bf16_f32 v38, v60, v61
    v_mfma_f32_16x16x32_bf16 v[188:191], a[192:195], v[40:43], v[188:191]
    v_exp_f32 v62, v62
    v_mfma_f32_16x16x32_bf16 v[208:211], a[196:199], v[40:43], v[208:211]
    ds_read_b128 a[124:127], v11 offset:32768
    v_mfma_f32_16x16x32_bf16 v[228:231], a[200:203], v[40:43], v[228:231]
    v_exp_f32 v63, v63
    v_mfma_f32_16x16x32_bf16 v[248:251], a[204:207], v[40:43], v[248:251]
    ds_read_b128 a[128:131], v8 offset:33792
    v_cvt_pk_bf16_f32 v39, v62, v63
    v_mfma_f32_16x16x32_bf16 a[220:223], a[248:251], v[40:43], a[220:223]
    ds_read_b128 a[132:135], v9 offset:33792
    ds_read_b128 a[136:139], v10 offset:33792
    v_mfma_f32_16x16x32_bf16 v[56:59], a[80:83], a[64:67], v[80:83]
    v_exp_f32 v48, v48
    v_mfma_f32_16x16x32_bf16 v[56:59], a[84:87], a[68:71], v[56:59]
    ds_read_b128 a[140:143], v11 offset:33792
    v_mfma_f32_16x16x32_bf16 v[56:59], a[88:91], a[72:75], v[56:59]
    v_exp_f32 v49, v49
    v_mfma_f32_16x16x32_bf16 v[56:59], a[92:95], a[76:79], v[56:59]
    v_cvt_pk_bf16_f32 v40, v48, v49
    v_mfma_f32_16x16x32_bf16 v[60:63], a[96:99], a[64:67], v[80:83]
    v_exp_f32 v50, v50
    v_mfma_f32_16x16x32_bf16 v[60:63], a[100:103], a[68:71], v[60:63]
    v_mfma_f32_16x16x32_bf16 v[60:63], a[104:107], a[72:75], v[60:63]
    v_exp_f32 v51, v51
    v_mfma_f32_16x16x32_bf16 v[60:63], a[108:111], a[76:79], v[60:63]
    v_cvt_pk_bf16_f32 v41, v50, v51
    v_mfma_f32_16x16x32_bf16 v[112:115], a[176:179], v[44:47], v[112:115]
    v_exp_f32 v52, v52
    v_mfma_f32_16x16x32_bf16 v[132:135], a[180:183], v[44:47], v[132:135]
    v_mfma_f32_16x16x32_bf16 v[152:155], a[184:187], v[44:47], v[152:155]
    v_exp_f32 v53, v53
    v_mfma_f32_16x16x32_bf16 v[172:175], a[188:191], v[44:47], v[172:175]
    v_cvt_pk_bf16_f32 v42, v52, v53
    v_mfma_f32_16x16x32_bf16 v[192:195], a[192:195], v[44:47], v[192:195]
    v_exp_f32 v54, v54
    v_mfma_f32_16x16x32_bf16 v[212:215], a[196:199], v[44:47], v[212:215]
    v_mfma_f32_16x16x32_bf16 v[232:235], a[200:203], v[44:47], v[232:235]
    v_exp_f32 v55, v55
    v_mfma_f32_16x16x32_bf16 v[252:255], a[204:207], v[44:47], v[252:255]
    s_waitcnt lgkmcnt(0)
    v_cvt_pk_bf16_f32 v43, v54, v55
    v_mfma_f32_16x16x32_bf16 a[224:227], a[248:251], v[44:47], a[224:227]
    v_mfma_f32_16x16x32_bf16 v[48:51], a[112:115], a[0:3], v[64:67]
    v_exp_f32 v56, v56
    v_mfma_f32_16x16x32_bf16 v[48:51], a[116:119], a[4:7], v[48:51]
    v_mfma_f32_16x16x32_bf16 v[48:51], a[120:123], a[8:11], v[48:51]
    v_exp_f32 v57, v57
    v_mfma_f32_16x16x32_bf16 v[48:51], a[124:127], a[12:15], v[48:51]
    v_cvt_pk_bf16_f32 v44, v56, v57
    v_mfma_f32_16x16x32_bf16 v[52:55], a[128:131], a[0:3], v[64:67]
    v_exp_f32 v58, v58
    v_mfma_f32_16x16x32_bf16 v[52:55], a[132:135], a[4:7], v[52:55]
    v_mfma_f32_16x16x32_bf16 v[52:55], a[136:139], a[8:11], v[52:55]
    v_exp_f32 v59, v59
    v_mfma_f32_16x16x32_bf16 v[52:55], a[140:143], a[12:15], v[52:55]
    v_cvt_pk_bf16_f32 v45, v58, v59
    v_mfma_f32_16x16x32_bf16 v[96:99], a[144:147], v[28:31], v[96:99]
    v_exp_f32 v60, v60
    v_mfma_f32_16x16x32_bf16 v[116:119], a[148:151], v[28:31], v[116:119]
    v_mfma_f32_16x16x32_bf16 v[136:139], a[152:155], v[28:31], v[136:139]
    v_exp_f32 v61, v61
    v_mfma_f32_16x16x32_bf16 v[156:159], a[156:159], v[28:31], v[156:159]
    s_add_u32 m0, s52, 53248
    v_cvt_pk_bf16_f32 v46, v60, v61
    s_add_u32 s57, s4, 16384
    buffer_load_dwordx4 v20, s[44:47], s4 offen offset:0 lds
    v_mfma_f32_16x16x32_bf16 v[176:179], a[160:163], v[28:31], v[176:179]
    v_exp_f32 v62, v62
    v_mfma_f32_16x16x32_bf16 v[196:199], a[164:167], v[28:31], v[196:199]
    buffer_load_dwordx4 v21, s[44:47], s4 offen offset:1024 lds
    v_mfma_f32_16x16x32_bf16 v[216:219], a[168:171], v[28:31], v[216:219]
    v_exp_f32 v63, v63
    v_mfma_f32_16x16x32_bf16 v[236:239], a[172:175], v[28:31], v[236:239]
    v_cvt_pk_bf16_f32 v47, v62, v63
    v_mfma_f32_16x16x32_bf16 a[208:211], a[248:251], v[28:31], a[208:211]
    buffer_load_dwordx4 v22, s[44:47], s4 offen offset:2048 lds
    v_mfma_f32_16x16x32_bf16 v[56:59], a[112:115], a[16:19], v[68:71]
    v_exp_f32 v48, v48
    v_mfma_f32_16x16x32_bf16 v[56:59], a[116:119], a[20:23], v[56:59]
    v_mfma_f32_16x16x32_bf16 v[56:59], a[120:123], a[24:27], v[56:59]
    v_exp_f32 v49, v49
    v_mfma_f32_16x16x32_bf16 v[56:59], a[124:127], a[28:31], v[56:59]
    buffer_load_dwordx4 v23, s[44:47], s4 offen offset:3072 lds
    v_cvt_pk_bf16_f32 v28, v48, v49
    v_mfma_f32_16x16x32_bf16 v[60:63], a[128:131], a[16:19], v[68:71]
    v_exp_f32 v50, v50
    v_mfma_f32_16x16x32_bf16 v[60:63], a[132:135], a[20:23], v[60:63]
    s_add_u32 m0, s52, 57344
    v_mfma_f32_16x16x32_bf16 v[60:63], a[136:139], a[24:27], v[60:63]
    v_exp_f32 v51, v51
    v_mfma_f32_16x16x32_bf16 v[60:63], a[140:143], a[28:31], v[60:63]
    buffer_load_dwordx4 v20, s[44:47], s57 offen offset:0 lds
    v_cvt_pk_bf16_f32 v29, v50, v51
    v_mfma_f32_16x16x32_bf16 v[100:103], a[144:147], v[32:35], v[100:103]
    v_exp_f32 v52, v52
    v_mfma_f32_16x16x32_bf16 v[120:123], a[148:151], v[32:35], v[120:123]
    buffer_load_dwordx4 v21, s[44:47], s57 offen offset:1024 lds
    v_mfma_f32_16x16x32_bf16 v[140:143], a[152:155], v[32:35], v[140:143]
    v_exp_f32 v53, v53
    v_mfma_f32_16x16x32_bf16 v[160:163], a[156:159], v[32:35], v[160:163]
    buffer_load_dwordx4 v22, s[44:47], s57 offen offset:2048 lds
    v_cvt_pk_bf16_f32 v30, v52, v53
    v_mfma_f32_16x16x32_bf16 v[180:183], a[160:163], v[32:35], v[180:183]
    v_exp_f32 v54, v54
    v_mfma_f32_16x16x32_bf16 v[200:203], a[164:167], v[32:35], v[200:203]
    v_mfma_f32_16x16x32_bf16 v[220:223], a[168:171], v[32:35], v[220:223]
    v_exp_f32 v55, v55
    v_mfma_f32_16x16x32_bf16 v[240:243], a[172:175], v[32:35], v[240:243]
    buffer_load_dwordx4 v23, s[44:47], s57 offen offset:3072 lds
    v_cvt_pk_bf16_f32 v31, v54, v55
    v_mfma_f32_16x16x32_bf16 a[212:215], a[248:251], v[32:35], a[212:215]
    v_mfma_f32_16x16x32_bf16 v[48:51], a[112:115], a[32:35], v[72:75]
    v_exp_f32 v56, v56
    v_mfma_f32_16x16x32_bf16 v[48:51], a[116:119], a[36:39], v[48:51]
    v_mfma_f32_16x16x32_bf16 v[48:51], a[120:123], a[40:43], v[48:51]
    v_exp_f32 v57, v57
    v_mfma_f32_16x16x32_bf16 v[48:51], a[124:127], a[44:47], v[48:51]
    s_add_u32 m0, s52, 86016
    v_cvt_pk_bf16_f32 v32, v56, v57
    s_add_u32 s57, s5, 16384
    buffer_load_dwordx4 v20, s[44:47], s5 offen offset:0 lds
    v_mfma_f32_16x16x32_bf16 v[52:55], a[128:131], a[32:35], v[72:75]
    v_exp_f32 v58, v58
    v_mfma_f32_16x16x32_bf16 v[52:55], a[132:135], a[36:39], v[52:55]
    buffer_load_dwordx4 v21, s[44:47], s5 offen offset:1024 lds
    s_waitcnt vmcnt(15)
    ds_read_b64_tr_b16 a[176:177], v12 offset:0
    v_mfma_f32_16x16x32_bf16 v[52:55], a[136:139], a[40:43], v[52:55]
    v_exp_f32 v59, v59
    v_mfma_f32_16x16x32_bf16 v[52:55], a[140:143], a[44:47], v[52:55]
    v_cvt_pk_bf16_f32 v33, v58, v59
    v_accvgpr_read_b32 v8, a235
    ds_read_b64_tr_b16 a[178:179], v12 offset:1024
    v_mfma_f32_16x16x32_bf16 v[104:107], a[144:147], v[36:39], v[104:107]
    v_exp_f32 v60, v60
    v_mfma_f32_16x16x32_bf16 v[124:127], a[148:151], v[36:39], v[124:127]
    buffer_load_dwordx4 v22, s[44:47], s5 offen offset:2048 lds
    v_accvgpr_read_b32 v9, a236
    v_accvgpr_read_b32 v10, a237
    v_mfma_f32_16x16x32_bf16 v[144:147], a[152:155], v[36:39], v[144:147]
    v_exp_f32 v61, v61
    v_mfma_f32_16x16x32_bf16 v[164:167], a[156:159], v[36:39], v[164:167]
    buffer_load_dwordx4 v23, s[44:47], s5 offen offset:3072 lds
    v_cvt_pk_bf16_f32 v34, v60, v61
    v_accvgpr_read_b32 v11, a238
    v_mfma_f32_16x16x32_bf16 v[184:187], a[160:163], v[36:39], v[184:187]
    v_exp_f32 v62, v62
    v_mfma_f32_16x16x32_bf16 v[204:207], a[164:167], v[36:39], v[204:207]
    v_accvgpr_read_b32 v24, a239
    v_accvgpr_read_b32 v25, a240
    ds_read_b64_tr_b16 a[180:181], v13 offset:0
    v_mfma_f32_16x16x32_bf16 v[224:227], a[168:171], v[36:39], v[224:227]
    v_exp_f32 v63, v63
    v_mfma_f32_16x16x32_bf16 v[244:247], a[172:175], v[36:39], v[244:247]
    s_add_u32 m0, s52, 90112
    v_cvt_pk_bf16_f32 v35, v62, v63
    ds_read_b64_tr_b16 a[182:183], v13 offset:1024
    v_mfma_f32_16x16x32_bf16 a[216:219], a[248:251], v[36:39], a[216:219]
    buffer_load_dwordx4 v20, s[44:47], s57 offen offset:0 lds
    ds_read_b64_tr_b16 a[184:185], v14 offset:0
    ds_read_b64_tr_b16 a[186:187], v14 offset:1024
    v_mfma_f32_16x16x32_bf16 v[56:59], a[112:115], a[48:51], v[76:79]
    v_exp_f32 v48, v48
    v_mfma_f32_16x16x32_bf16 v[56:59], a[116:119], a[52:55], v[56:59]
    buffer_load_dwordx4 v21, s[44:47], s57 offen offset:1024 lds
    ds_read_b64_tr_b16 a[188:189], v15 offset:0
    ds_read_b64_tr_b16 a[190:191], v15 offset:1024
    v_mfma_f32_16x16x32_bf16 v[56:59], a[120:123], a[56:59], v[56:59]
    v_exp_f32 v49, v49
    v_mfma_f32_16x16x32_bf16 v[56:59], a[124:127], a[60:63], v[56:59]
    buffer_load_dwordx4 v22, s[44:47], s57 offen offset:2048 lds
    v_cvt_pk_bf16_f32 v36, v48, v49
    ds_read_b64_tr_b16 a[192:193], v16 offset:0
    v_mfma_f32_16x16x32_bf16 v[60:63], a[128:131], a[48:51], v[76:79]
    v_exp_f32 v50, v50
    v_mfma_f32_16x16x32_bf16 v[60:63], a[132:135], a[52:55], v[60:63]
    ds_read_b64_tr_b16 a[194:195], v16 offset:1024
    ds_read_b64_tr_b16 a[196:197], v17 offset:0
    ds_read_b64_tr_b16 a[198:199], v17 offset:1024
    v_mfma_f32_16x16x32_bf16 v[60:63], a[136:139], a[56:59], v[60:63]
    v_exp_f32 v51, v51
    v_mfma_f32_16x16x32_bf16 v[60:63], a[140:143], a[60:63], v[60:63]
    buffer_load_dwordx4 v23, s[44:47], s57 offen offset:3072 lds
    v_cvt_pk_bf16_f32 v37, v50, v51
    ds_read_b64_tr_b16 a[200:201], v18 offset:0
    v_mfma_f32_16x16x32_bf16 v[108:111], a[144:147], v[40:43], v[108:111]
    v_exp_f32 v52, v52
    v_mfma_f32_16x16x32_bf16 v[128:131], a[148:151], v[40:43], v[128:131]
    ds_read_b64_tr_b16 a[202:203], v18 offset:1024
    ds_read_b64_tr_b16 a[204:205], v19 offset:0
    ds_read_b64_tr_b16 a[206:207], v19 offset:1024
    v_mfma_f32_16x16x32_bf16 v[148:151], a[152:155], v[40:43], v[148:151]
    v_exp_f32 v53, v53
    v_mfma_f32_16x16x32_bf16 v[168:171], a[156:159], v[40:43], v[168:171]
    s_waitcnt vmcnt(16)
    v_cvt_pk_bf16_f32 v38, v52, v53
    v_mov_b32 v2, 0
    s_add_u32 m0, s52, 118784
    s_add_u32 s57, s6, 16384
    buffer_load_dwordx4 v20, s[44:47], s6 offen offset:0 lds
    v_mfma_f32_16x16x32_bf16 v[188:191], a[160:163], v[40:43], v[188:191]
    v_exp_f32 v54, v54
    v_mfma_f32_16x16x32_bf16 v[208:211], a[164:167], v[40:43], v[208:211]
    v_mov_b32 v3, s63
    v_mfma_f32_16x16x32_bf16 v[228:231], a[168:171], v[40:43], v[228:231]
    v_exp_f32 v55, v55
    v_mfma_f32_16x16x32_bf16 v[248:251], a[172:175], v[40:43], v[248:251]
    buffer_load_dwordx4 v21, s[44:47], s6 offen offset:1024 lds
    v_cvt_pk_bf16_f32 v39, v54, v55
    v_mfma_f32_16x16x32_bf16 a[220:223], a[248:251], v[40:43], a[220:223]
    s_waitcnt vmcnt(10) lgkmcnt(0)
    s_barrier
    v_mfma_f32_16x16x32_bf16 v[136:139], a[184:187], v[28:31], v[136:139]
    s_mov_b64 exec, 1
    global_store_dword v3, v2, s[18:19] offset:0 sc1
    s_mov_b64 exec, -1
    buffer_load_dwordx4 v22, s[44:47], s6 offen offset:2048 lds
    v_mfma_f32_16x16x32_bf16 v[156:159], a[188:191], v[28:31], v[156:159]
    v_accvgpr_read_b32 v12, a245
    v_accvgpr_read_b32 v13, a246
    ds_read_b64_tr_b16 a[80:81], v12 offset:0
    v_mfma_f32_16x16x32_bf16 v[176:179], a[192:195], v[28:31], v[176:179]
    ds_read_b64_tr_b16 a[82:83], v12 offset:4096
    ds_read_b64_tr_b16 a[84:85], v13 offset:0
    ds_read_b64_tr_b16 a[86:87], v13 offset:4096
    v_mfma_f32_16x16x32_bf16 v[196:199], a[196:199], v[28:31], v[196:199]
    buffer_load_dwordx4 v23, s[44:47], s6 offen offset:3072 lds
    ds_read_b64_tr_b16 a[88:89], v12 offset:8192
    ds_read_b64_tr_b16 a[90:91], v12 offset:12288
    v_mfma_f32_16x16x32_bf16 v[216:219], a[200:203], v[28:31], v[216:219]
    ds_read_b64_tr_b16 a[92:93], v13 offset:8192
    ds_read_b64_tr_b16 a[94:95], v13 offset:12288
    ds_read_b64_tr_b16 a[96:97], v12 offset:16384
    v_mfma_f32_16x16x32_bf16 v[236:239], a[204:207], v[28:31], v[236:239]
    ds_read_b64_tr_b16 a[98:99], v12 offset:20480
    v_cvt_pk_bf16_f32 v84, v136, v137
    v_cvt_pk_bf16_f32 v85, v138, v139
    v_mfma_f32_16x16x32_bf16 v[96:99], a[176:179], v[28:31], v[96:99]
    s_add_u32 m0, s52, 122880
    v_cvt_pk_bf16_f32 v86, v156, v157
    v_cvt_pk_bf16_f32 v87, v158, v159
    v_mfma_f32_16x16x32_bf16 v[116:119], a[180:183], v[28:31], v[116:119]
    buffer_load_dwordx4 v20, s[44:47], s57 offen offset:0 lds
    ds_read_b64_tr_b16 a[100:101], v13 offset:16384
    ds_read_b64_tr_b16 a[102:103], v13 offset:20480
    v_mfma_f32_16x16x32_bf16 a[208:211], a[248:251], v[28:31], a[208:211]
    ds_write_b128 v8, v[84:87] offset:0
    v_mfma_f32_16x16x32_bf16 v[48:51], a[112:115], a[64:67], v[80:83]
    v_exp_f32 v56, v56
    v_mfma_f32_16x16x32_bf16 v[48:51], a[116:119], a[68:71], v[48:51]
    buffer_load_dwordx4 v21, s[44:47], s57 offen offset:1024 lds
    v_cvt_pk_bf16_f32 v88, v176, v177
    v_cvt_pk_bf16_f32 v89, v178, v179
    v_mfma_f32_16x16x32_bf16 v[48:51], a[120:123], a[72:75], v[48:51]
    v_exp_f32 v57, v57
    v_mfma_f32_16x16x32_bf16 v[48:51], a[124:127], a[76:79], v[48:51]
    buffer_load_dwordx4 v22, s[44:47], s57 offen offset:2048 lds
    v_cvt_pk_bf16_f32 v40, v56, v57
    v_cvt_pk_bf16_f32 v90, v196, v197
    v_mfma_f32_16x16x32_bf16 v[52:55], a[128:131], a[64:67], v[80:83]
    v_exp_f32 v58, v58
    v_mfma_f32_16x16x32_bf16 v[52:55], a[132:135], a[68:71], v[52:55]
    ds_read_b64_tr_b16 a[104:105], v12 offset:24576
    v_cvt_pk_bf16_f32 v91, v198, v199
    ds_read_b64_tr_b16 a[106:107], v12 offset:28672
    v_mfma_f32_16x16x32_bf16 v[52:55], a[136:139], a[72:75], v[52:55]
    v_exp_f32 v59, v59
    v_mfma_f32_16x16x32_bf16 v[52:55], a[140:143], a[76:79], v[52:55]
    buffer_load_dwordx4 v23, s[44:47], s57 offen offset:3072 lds
    v_cvt_pk_bf16_f32 v41, v58, v59
    ds_read_b64_tr_b16 a[108:109], v13 offset:24576
    v_mfma_f32_16x16x32_bf16 v[112:115], a[144:147], v[44:47], v[112:115]
    v_exp_f32 v60, v60
    v_mfma_f32_16x16x32_bf16 v[132:135], a[148:151], v[44:47], v[132:135]
    ds_write_b128 v9, v[88:91] offset:0
    v_mfma_f32_16x16x32_bf16 v[152:155], a[152:155], v[44:47], v[152:155]
    v_exp_f32 v61, v61
    v_mfma_f32_16x16x32_bf16 v[172:175], a[156:159], v[44:47], v[172:175]
    ds_read_b64_tr_b16 a[110:111], v13 offset:28672
    v_cvt_pk_bf16_f32 v42, v60, v61
    v_cvt_pk_bf16_f32 v84, v216, v217
    v_mfma_f32_16x16x32_bf16 v[192:195], a[160:163], v[44:47], v[192:195]
    v_exp_f32 v62, v62
    v_mfma_f32_16x16x32_bf16 v[212:215], a[164:167], v[44:47], v[212:215]
    v_cvt_pk_bf16_f32 v85, v218, v219
    v_cvt_pk_bf16_f32 v86, v236, v237
    v_mfma_f32_16x16x32_bf16 v[232:235], a[168:171], v[44:47], v[232:235]
    v_exp_f32 v63, v63
    v_mfma_f32_16x16x32_bf16 v[252:255], a[172:175], v[44:47], v[252:255]
    v_cvt_pk_bf16_f32 v43, v62, v63
    v_cvt_pk_bf16_f32 v87, v238, v239
    v_mfma_f32_16x16x32_bf16 a[224:227], a[248:251], v[44:47], a[224:227]
    ds_write_b128 v10, v[84:87] offset:0
    v_mfma_f32_16x16x32_bf16 v[140:143], a[184:187], v[32:35], v[140:143]
    ds_write_b32 v24, a208 offset:0
    v_add_u32 v14, 86016, v26
    v_add_u32 v15, s95, v14
    v_mfma_f32_16x16x32_bf16 v[160:163], a[188:191], v[32:35], v[160:163]
    s_waitcnt vmcnt(9) lgkmcnt(0)
    s_barrier
    s_add_u32 m0, s52, 53248
    s_add_u32 s57, s7, 16384
    v_mfma_f32_16x16x32_bf16 v[180:183], a[192:195], v[32:35], v[180:183]
    buffer_load_dwordx4 v20, s[44:47], s7 offen offset:0 lds
    ds_read_b128 v[64:67], v25 offset:0
    ds_read_b128 a[112:115], v11 offset:0
    v_mfma_f32_16x16x32_bf16 v[200:203], a[196:199], v[32:35], v[200:203]
    buffer_load_dwordx4 v21, s[44:47], s7 offen offset:1024 lds
    ds_read_b128 a[116:119], v11 offset:1024
    ds_read_b128 a[120:123], v11 offset:2048
    v_mfma_f32_16x16x32_bf16 v[220:223], a[200:203], v[32:35], v[220:223]
    buffer_load_dwordx4 v22, s[44:47], s7 offen offset:2048 lds
    ds_read_b64_tr_b16 a[0:1], v12 offset:32768
    ds_read_b64_tr_b16 a[2:3], v12 offset:36864
    v_mfma_f32_16x16x32_bf16 v[240:243], a[204:207], v[32:35], v[240:243]
    buffer_load_dwordx4 v23, s[44:47], s7 offen offset:3072 lds
    s_waitcnt lgkmcnt(5)
    v_add_f32 v64, v64, v65
    v_mfma_f32_16x16x32_bf16 v[100:103], a[176:179], v[32:35], v[100:103]
    s_add_u32 m0, s52, 57344
    v_add_f32 v66, v66, v67
    v_add_f32 v64, v64, v66
    v_mfma_f32_16x16x32_bf16 v[120:123], a[180:183], v[32:35], v[120:123]
    buffer_load_dwordx4 v20, s[44:47], s57 offen offset:0 lds
    v_subrev_u32 v65, 562036736, v64
    ds_read_b64_tr_b16 a[4:5], v13 offset:32768
    v_mfma_f32_16x16x32_bf16 a[212:215], a[248:251], v[32:35], a[212:215]
    buffer_load_dwordx4 v21, s[44:47], s57 offen offset:1024 lds
    ds_read_b64_tr_b16 a[6:7], v13 offset:36864
    ds_read_b64_tr_b16 a[8:9], v12 offset:40960
    s_waitcnt lgkmcnt(5)
    v_mfma_f32_16x16x32_bf16 v[96:99], a[230:233], a[112:115], v[96:99]
    v_exp_f32 v48, v48
    v_mfma_f32_16x16x32_bf16 v[116:119], a[228:231], a[112:115], v[116:119]
    buffer_load_dwordx4 v22, s[44:47], s57 offen offset:2048 lds
    ds_read_b64_tr_b16 a[10:11], v12 offset:45056
    ds_read_b64_tr_b16 a[12:13], v13 offset:40960
    v_mfma_f32_16x16x32_bf16 v[96:99], a[230:233], a[116:119], v[96:99]
    v_exp_f32 v49, v49
    v_mfma_f32_16x16x32_bf16 v[116:119], a[228:231], a[116:119], v[116:119]
    buffer_load_dwordx4 v23, s[44:47], s57 offen offset:3072 lds
    v_cvt_pk_bf16_f32 v44, v48, v49
    ds_read_b64_tr_b16 a[14:15], v13 offset:45056
    v_mfma_f32_16x16x32_bf16 v[96:99], a[230:233], a[120:123], v[96:99]
    v_exp_f32 v50, v50
    v_mfma_f32_16x16x32_bf16 v[116:119], a[228:231], a[120:123], v[116:119]
    v_cmp_lt_u32 vcc, s23, v65
    v_rcp_f32 v64, v64
    s_cbranch_vccnz L_fallback
    v_mfma_f32_16x16x32_bf16 v[144:147], a[184:187], v[36:39], v[144:147]
    v_exp_f32 v51, v51
    v_mfma_f32_16x16x32_bf16 v[164:167], a[188:191], v[36:39], v[164:167]
    ds_read_b64_tr_b16 a[16:17], v12 offset:49152
    v_cvt_pk_bf16_f32 v45, v50, v51
    ds_read_b64_tr_b16 a[18:19], v12 offset:53248
    v_mfma_f32_16x16x32_bf16 v[184:187], a[192:195], v[36:39], v[184:187]
    v_exp_f32 v52, v52
    v_mfma_f32_16x16x32_bf16 v[204:207], a[196:199], v[36:39], v[204:207]
    ds_read_b64_tr_b16 a[20:21], v13 offset:49152
    ds_read_b64_tr_b16 a[22:23], v13 offset:53248
    ds_read_b64_tr_b16 a[24:25], v12 offset:57344
    v_mfma_f32_16x16x32_bf16 v[224:227], a[200:203], v[36:39], v[224:227]
    v_exp_f32 v53, v53
    v_mfma_f32_16x16x32_bf16 v[244:247], a[204:207], v[36:39], v[244:247]
    ds_read_b64_tr_b16 a[26:27], v12 offset:61440
    v_cvt_pk_bf16_f32 v46, v52, v53
    ds_read_b64_tr_b16 a[28:29], v13 offset:57344
    v_mfma_f32_16x16x32_bf16 v[104:107], a[176:179], v[36:39], v[104:107]
    v_exp_f32 v54, v54
    v_mfma_f32_16x16x32_bf16 v[124:127], a[180:183], v[36:39], v[124:127]
    ds_read_b64_tr_b16 a[30:31], v13 offset:61440
    v_accvgpr_read_b32 v17, a234
    v_add_u32 v19, s95, v26
    s_mov_b64 exec, 15
    buffer_load_dword v18, v17, s[24:27], 0 offen sc1
    s_mov_b64 exec, -1
    v_mfma_f32_16x16x32_bf16 a[216:219], a[248:251], v[36:39], a[216:219]
    v_exp_f32 v55, v55
    v_mfma_f32_16x16x32_bf16 v[148:151], a[184:187], v[40:43], v[148:151]
    v_cvt_pk_bf16_f32 v47, v54, v55
    v_mul_f32 v96, v64, v96
    v_mfma_f32_16x16x32_bf16 v[168:171], a[188:191], v[40:43], v[168:171]
    v_mul_f32 v97, v64, v97
    v_mul_f32 v98, v64, v98
    v_mfma_f32_16x16x32_bf16 v[188:191], a[192:195], v[40:43], v[188:191]
    v_mul_f32 v99, v64, v99
    v_mul_f32 v116, v64, v116
    v_mfma_f32_16x16x32_bf16 v[208:211], a[196:199], v[40:43], v[208:211]
    v_mul_f32 v117, v64, v117
    v_mul_f32 v118, v64, v118
    v_mfma_f32_16x16x32_bf16 v[228:231], a[200:203], v[40:43], v[228:231]
    v_mul_f32 v119, v64, v119
    v_cvt_pk_bf16_f32 v176, v96, v97
    v_mfma_f32_16x16x32_bf16 v[248:251], a[204:207], v[40:43], v[248:251]
    v_cvt_pk_bf16_f32 v177, v98, v99
    v_cvt_pk_bf16_f32 v178, v116, v117
    v_mfma_f32_16x16x32_bf16 v[108:111], a[176:179], v[40:43], v[108:111]
    v_cvt_pk_bf16_f32 v179, v118, v119
    v_min_u32 v176, -2, v176
    v_mfma_f32_16x16x32_bf16 v[128:131], a[180:183], v[40:43], v[128:131]
    buffer_store_dwordx4 v[176:179], v26, s[40:43], s60 offen offset:0 sc1
    v_mfma_f32_16x16x32_bf16 a[220:223], a[248:251], v[40:43], a[220:223]
    ds_write_b128 v19, v[176:179] offset:36864
    v_mfma_f32_16x16x32_bf16 v[152:155], a[184:187], v[44:47], v[152:155]
    buffer_store_dwordx4 v[92:95], v26, s[64:67], s49 offen offset:0 sc1
    v_mfma_f32_16x16x32_bf16 v[172:175], a[188:191], v[44:47], v[172:175]
    buffer_store_dwordx4 v[92:95], v26, s[64:67], s49 offen offset:1024 sc1
    v_mfma_f32_16x16x32_bf16 v[192:195], a[192:195], v[44:47], v[192:195]
    buffer_store_dwordx4 v[92:95], v26, s[64:67], s49 offen offset:2048 sc1
    v_mfma_f32_16x16x32_bf16 v[212:215], a[196:199], v[44:47], v[212:215]
    v_cvt_pk_bf16_f32 v88, v140, v141
    v_cvt_pk_bf16_f32 v89, v142, v143
    v_mfma_f32_16x16x32_bf16 v[232:235], a[200:203], v[44:47], v[232:235]
    v_cvt_pk_bf16_f32 v90, v160, v161
    v_cvt_pk_bf16_f32 v91, v162, v163
    v_mfma_f32_16x16x32_bf16 v[252:255], a[204:207], v[44:47], v[252:255]
    ds_write_b128 v8, v[88:91] offset:12288
    v_mfma_f32_16x16x32_bf16 v[112:115], a[176:179], v[44:47], v[112:115]
    v_cvt_pk_bf16_f32 v84, v180, v181
    v_cvt_pk_bf16_f32 v85, v182, v183
    v_mfma_f32_16x16x32_bf16 v[132:135], a[180:183], v[44:47], v[132:135]
    v_cvt_pk_bf16_f32 v86, v200, v201
    v_cvt_pk_bf16_f32 v87, v202, v203
    v_mfma_f32_16x16x32_bf16 a[224:227], a[248:251], v[44:47], a[224:227]
    ds_write_b128 v9, v[84:87] offset:12288
    v_cvt_pk_bf16_f32 v88, v220, v221
    v_cvt_pk_bf16_f32 v89, v222, v223
    v_cvt_pk_bf16_f32 v90, v240, v241
    v_cvt_pk_bf16_f32 v91, v242, v243
    ds_write_b128 v10, v[88:91] offset:12288
    ds_write_b32 v24, a212 offset:256
    s_waitcnt vmcnt(5) lgkmcnt(0)
    s_barrier
    ds_read_b128 v[68:71], v25 offset:256
    ds_read_b128 a[124:127], v11 offset:12288
    ds_read_b128 a[128:131], v11 offset:13312
    ds_read_b128 a[132:135], v11 offset:14336
    ds_read_b128 v[48:51], v26 offset:36864
    ds_read_b128 v[52:55], v26 offset:37888
    ds_read_b128 v[56:59], v26 offset:38912
    ds_read_b128 v[60:63], v26 offset:39936
    v_cvt_pk_bf16_f32 v84, v144, v145
    v_cvt_pk_bf16_f32 v85, v146, v147
    v_cvt_pk_bf16_f32 v86, v164, v165
    v_cvt_pk_bf16_f32 v87, v166, v167
    ds_write_b128 v8, v[84:87] offset:24576
    s_waitcnt lgkmcnt(5)
    v_mfma_f32_16x16x32_bf16 v[100:103], a[230:233], a[124:127], v[100:103]
    s_waitcnt vmcnt(4)
    v_cmp_eq_u32 vcc, -1, v18
    s_nop 0
    s_and_b32 s58, vcc_lo, 15
    s_cbranch_scc1 L_waitf
L_fok:
    v_mfma_f32_16x16x32_bf16 v[120:123], a[228:231], a[124:127], v[120:123]
    v_cvt_pk_bf16_f32 v88, v184, v185
    v_cvt_pk_bf16_f32 v89, v186, v187
    v_mfma_f32_16x16x32_bf16 v[100:103], a[230:233], a[128:131], v[100:103]
    v_cvt_pk_bf16_f32 v90, v204, v205
    v_cvt_pk_bf16_f32 v91, v206, v207
    v_mfma_f32_16x16x32_bf16 v[120:123], a[228:231], a[128:131], v[120:123]
    ds_write_b128 v9, v[88:91] offset:24576
    v_mfma_f32_16x16x32_bf16 v[100:103], a[230:233], a[132:135], v[100:103]
    v_cvt_pk_bf16_f32 v84, v224, v225
    v_cvt_pk_bf16_f32 v85, v226, v227
    v_mfma_f32_16x16x32_bf16 v[120:123], a[228:231], a[132:135], v[120:123]
    v_cvt_pk_bf16_f32 v86, v244, v245
    v_cvt_pk_bf16_f32 v87, v246, v247
    s_waitcnt lgkmcnt(2)
    v_mfma_f32_16x16x32_bf16 v[136:139], a[80:83], v[48:51], 0
    ds_write_b128 v10, v[84:87] offset:24576
    v_mfma_f32_16x16x32_bf16 v[156:159], a[84:87], v[48:51], 0
    ds_write_b32 v24, a216 offset:512
    s_waitcnt lgkmcnt(11)
    v_add_f32 v68, v68, v69
    v_mfma_f32_16x16x32_bf16 v[136:139], a[88:91], v[52:55], v[136:139]
    v_add_f32 v70, v70, v71
    v_add_f32 v68, v68, v70
    v_mfma_f32_16x16x32_bf16 v[156:159], a[92:95], v[52:55], v[156:159]
    v_subrev_u32 v69, 562036736, v68
    v_add_u32 v12, 65536, v12
    v_cmp_lt_u32 vcc, s23, v69
    v_rcp_f32 v68, v68
    s_cbranch_vccnz L_fallback
    v_mul_f32 v100, v68, v100
    v_mul_f32 v101, v68, v101
    v_mul_f32 v102, v68, v102
    v_mul_f32 v103, v68, v103
    v_mul_f32 v120, v68, v120
    v_mul_f32 v121, v68, v121
    v_mul_f32 v122, v68, v122
    v_mul_f32 v123, v68, v123
    v_cvt_pk_bf16_f32 v180, v100, v101
    v_cvt_pk_bf16_f32 v181, v102, v103
    v_cvt_pk_bf16_f32 v182, v120, v121
    v_cvt_pk_bf16_f32 v183, v122, v123
    v_min_u32 v180, -2, v180
    buffer_store_dwordx4 v[180:183], v26, s[40:43], s60 offen offset:1024 sc1
    ds_write_b128 v19, v[180:183] offset:40960
    buffer_store_dwordx4 v[92:95], v26, s[64:67], s49 offen offset:3072 sc1
    buffer_store_dwordx4 v[92:95], v26, s[64:67], s51 offen offset:0 sc1
    v_mfma_f32_16x16x32_bf16 v[136:139], a[96:99], v[56:59], v[136:139]
    v_add_u32 v13, 65536, v13
    ds_read_b64_tr_b16 a[32:33], v12 offset:0
    ds_read_b64_tr_b16 a[34:35], v12 offset:4096
    v_mfma_f32_16x16x32_bf16 v[156:159], a[100:103], v[56:59], v[156:159]
    ds_read_b64_tr_b16 a[36:37], v13 offset:0
    ds_read_b64_tr_b16 a[38:39], v13 offset:4096
    ds_read_b64_tr_b16 a[40:41], v12 offset:8192
    v_mfma_f32_16x16x32_bf16 v[136:139], a[104:107], v[60:63], v[136:139]
    s_waitcnt lgkmcnt(5)
    s_barrier
    v_cvt_pk_bf16_f32 v88, v148, v149
    v_mfma_f32_16x16x32_bf16 v[156:159], a[108:111], v[60:63], v[156:159]
    ds_read_b64_tr_b16 a[42:43], v12 offset:12288
    v_cvt_pk_bf16_f32 v89, v150, v151
    v_cvt_pk_bf16_f32 v90, v168, v169
    ds_read_b64_tr_b16 a[44:45], v13 offset:8192
    ds_read_b64_tr_b16 a[46:47], v13 offset:12288
    ds_read_b128 v[72:75], v25 offset:512
    ds_read_b128 a[64:67], v11 offset:24576
    ds_read_b128 a[68:71], v11 offset:25600
    ds_read_b128 a[72:75], v11 offset:26624
    ds_read_b128 v[48:51], v26 offset:40960
    ds_read_b128 v[52:55], v26 offset:41984
    ds_read_b128 v[56:59], v26 offset:43008
    ds_read_b128 v[60:63], v26 offset:44032
    v_cvt_pk_bf16_f32 v91, v170, v171
    ds_write_b128 v8, v[88:91] offset:0
    s_waitcnt lgkmcnt(5)
    v_mfma_f32_16x16x32_bf16 v[104:107], a[230:233], a[64:67], v[104:107]
    ds_read_b64_tr_b16 a[48:49], v12 offset:16384
    v_cvt_pk_bf16_f32 v84, v188, v189
    v_cvt_pk_bf16_f32 v85, v190, v191
    v_mfma_f32_16x16x32_bf16 v[124:127], a[228:231], a[64:67], v[124:127]
    ds_read_b64_tr_b16 a[50:51], v12 offset:20480
    v_cvt_pk_bf16_f32 v86, v208, v209
    v_cvt_pk_bf16_f32 v87, v210, v211
    v_mfma_f32_16x16x32_bf16 v[104:107], a[230:233], a[68:71], v[104:107]
    ds_write_b128 v9, v[84:87] offset:0
    v_mfma_f32_16x16x32_bf16 v[124:127], a[228:231], a[68:71], v[124:127]
    ds_read_b64_tr_b16 a[52:53], v13 offset:16384
    v_cvt_pk_bf16_f32 v88, v228, v229
    v_cvt_pk_bf16_f32 v89, v230, v231
    v_mfma_f32_16x16x32_bf16 v[104:107], a[230:233], a[72:75], v[104:107]
    ds_read_b64_tr_b16 a[54:55], v13 offset:20480
    v_cvt_pk_bf16_f32 v90, v248, v249
    v_cvt_pk_bf16_f32 v91, v250, v251
    v_mfma_f32_16x16x32_bf16 v[124:127], a[228:231], a[72:75], v[124:127]
    ds_write_b128 v10, v[88:91] offset:0
    s_waitcnt lgkmcnt(7)
    v_mfma_f32_16x16x32_bf16 v[140:143], a[80:83], v[48:51], 0
    ds_write_b32 v24, a220 offset:768
    s_waitcnt lgkmcnt(15)
    v_add_f32 v72, v72, v73
    v_mfma_f32_16x16x32_bf16 v[160:163], a[84:87], v[48:51], 0
    ds_read_b64_tr_b16 a[56:57], v12 offset:24576
    v_add_f32 v74, v74, v75
    v_add_f32 v72, v72, v74
    v_mfma_f32_16x16x32_bf16 v[140:143], a[88:91], v[52:55], v[140:143]
    v_subrev_u32 v73, 562036736, v72
    ds_read_b64_tr_b16 a[58:59], v12 offset:28672
    ds_read_b64_tr_b16 a[60:61], v13 offset:24576
    v_mfma_f32_16x16x32_bf16 v[160:163], a[92:95], v[52:55], v[160:163]
    v_cmp_lt_u32 vcc, s23, v73
    v_rcp_f32 v72, v72
    s_cbranch_vccnz L_fallback
    v_mul_f32 v104, v72, v104
    v_mul_f32 v105, v72, v105
    v_mul_f32 v106, v72, v106
    v_mul_f32 v107, v72, v107
    v_mul_f32 v124, v72, v124
    v_mul_f32 v125, v72, v125
    v_mul_f32 v126, v72, v126
    v_mul_f32 v127, v72, v127
    v_cvt_pk_bf16_f32 v184, v104, v105
    v_cvt_pk_bf16_f32 v185, v106, v107
    v_cvt_pk_bf16_f32 v186, v124, v125
    v_cvt_pk_bf16_f32 v187, v126, v127
    v_min_u32 v184, -2, v184
    buffer_store_dwordx4 v[184:187], v26, s[40:43], s60 offen offset:2048 sc1
    ds_write_b128 v19, v[184:187] offset:45056
    v_mfma_f32_16x16x32_bf16 v[140:143], a[96:99], v[56:59], v[140:143]
    s_add_u32 m0, s95, 90112
    s_nop 0
    buffer_load_dwordx4 v26, s[40:43], s9 offen offset:0 sc1 lds
    s_add_u32 m0, s95, 94208
    s_nop 0
    buffer_load_dwordx4 v26, s[40:43], s10 offen offset:0 sc1 lds
    v_mfma_f32_16x16x32_bf16 v[160:163], a[100:103], v[56:59], v[160:163]
    s_add_u32 m0, s95, 98304
    s_nop 0
    buffer_load_dwordx4 v26, s[40:43], s11 offen offset:0 sc1 lds
    v_mfma_f32_16x16x32_bf16 v[140:143], a[104:107], v[60:63], v[140:143]
    ds_read_b64_tr_b16 a[62:63], v13 offset:28672
    v_subrev_u32 v12, 65536, v12
    v_subrev_u32 v13, 65536, v13
    v_mfma_f32_16x16x32_bf16 v[160:163], a[108:111], v[60:63], v[160:163]
    s_waitcnt lgkmcnt(0)
    s_barrier
    ds_read_b128 v[76:79], v25 offset:768
    ds_read_b128 a[112:115], v11 offset:0
    ds_read_b128 a[116:119], v11 offset:1024
    ds_read_b128 a[120:123], v11 offset:2048
    ds_read_b128 v[48:51], v26 offset:45056
    ds_read_b128 v[52:55], v26 offset:46080
    ds_read_b128 v[56:59], v26 offset:47104
    ds_read_b128 v[60:63], v26 offset:48128
    v_cvt_pk_bf16_f32 v84, v152, v153
    v_cvt_pk_bf16_f32 v85, v154, v155
    v_cvt_pk_bf16_f32 v86, v172, v173
    v_cvt_pk_bf16_f32 v87, v174, v175
    ds_write_b128 v8, v[84:87] offset:12288
    s_waitcnt lgkmcnt(5)
    v_mfma_f32_16x16x32_bf16 v[108:111], a[230:233], a[112:115], v[108:111]
    ds_read_b64_tr_b16 a[144:145], v12 offset:0
    v_cvt_pk_bf16_f32 v88, v192, v193
    v_cvt_pk_bf16_f32 v89, v194, v195
    v_mfma_f32_16x16x32_bf16 v[128:131], a[228:231], a[112:115], v[128:131]
    ds_read_b64_tr_b16 a[146:147], v12 offset:4096
    v_cvt_pk_bf16_f32 v90, v212, v213
    v_cvt_pk_bf16_f32 v91, v214, v215
    v_mfma_f32_16x16x32_bf16 v[108:111], a[230:233], a[116:119], v[108:111]
    ds_write_b128 v9, v[88:91] offset:12288
    v_mfma_f32_16x16x32_bf16 v[128:131], a[228:231], a[116:119], v[128:131]
    ds_read_b64_tr_b16 a[148:149], v13 offset:0
    v_cvt_pk_bf16_f32 v84, v232, v233
    v_cvt_pk_bf16_f32 v85, v234, v235
    v_mfma_f32_16x16x32_bf16 v[108:111], a[230:233], a[120:123], v[108:111]
    ds_read_b64_tr_b16 a[150:151], v13 offset:4096
    v_cvt_pk_bf16_f32 v86, v252, v253
    v_cvt_pk_bf16_f32 v87, v254, v255
    v_mfma_f32_16x16x32_bf16 v[128:131], a[228:231], a[120:123], v[128:131]
    ds_write_b128 v10, v[84:87] offset:12288
    s_waitcnt lgkmcnt(7)
    v_mfma_f32_16x16x32_bf16 v[144:147], a[80:83], v[48:51], 0
    ds_write_b32 v24, a224 offset:1024
    s_waitcnt lgkmcnt(15)
    v_add_f32 v76, v76, v77
    v_mfma_f32_16x16x32_bf16 v[164:167], a[84:87], v[48:51], 0
    ds_read_b64_tr_b16 a[152:153], v12 offset:8192
    v_add_f32 v78, v78, v79
    v_add_f32 v76, v76, v78
    v_mfma_f32_16x16x32_bf16 v[144:147], a[88:91], v[52:55], v[144:147]
    v_subrev_u32 v77, 562036736, v76
    ds_read_b64_tr_b16 a[154:155], v12 offset:12288
    ds_read_b64_tr_b16 a[156:157], v13 offset:8192
    v_mfma_f32_16x16x32_bf16 v[164:167], a[92:95], v[52:55], v[164:167]
    v_cmp_lt_u32 vcc, s23, v77
    v_rcp_f32 v76, v76
    s_cbranch_vccnz L_fallback
    v_mul_f32 v108, v76, v108
    v_mul_f32 v109, v76, v109
    v_mul_f32 v110, v76, v110
    v_mul_f32 v111, v76, v111
    v_mul_f32 v128, v76, v128
    v_mul_f32 v129, v76, v129
    v_mul_f32 v130, v76, v130
    v_mul_f32 v131, v76, v131
    v_cvt_pk_bf16_f32 v188, v108, v109
    v_cvt_pk_bf16_f32 v189, v110, v111
    v_cvt_pk_bf16_f32 v190, v128, v129
    v_cvt_pk_bf16_f32 v191, v130, v131
    v_min_u32 v188, -2, v188
    buffer_store_dwordx4 v[188:191], v26, s[40:43], s60 offen offset:3072 sc1
    ds_write_b128 v19, v[188:191] offset:49152
    v_mfma_f32_16x16x32_bf16 v[144:147], a[96:99], v[56:59], v[144:147]
    s_waitcnt vmcnt(5)
    v_mov_b32 v2, 0
    v_mov_b32 v3, s63
    s_add_u32 m0, s95, 105472
    s_nop 0
    buffer_load_dwordx4 v26, s[40:43], s9 offen offset:1024 sc1 lds
    v_mfma_f32_16x16x32_bf16 v[164:167], a[100:103], v[56:59], v[164:167]
    s_mov_b64 exec, 1
    global_store_dword v3, v2, s[18:19] offset:4 sc1
    s_mov_b64 exec, -1
    s_add_u32 m0, s95, 109568
    s_nop 0
    buffer_load_dwordx4 v26, s[40:43], s10 offen offset:1024 sc1 lds
    v_mfma_f32_16x16x32_bf16 v[144:147], a[104:107], v[60:63], v[144:147]
    s_add_u32 m0, s95, 113664
    s_nop 0
    buffer_load_dwordx4 v26, s[40:43], s11 offen offset:1024 sc1 lds
    v_mfma_f32_16x16x32_bf16 v[164:167], a[108:111], v[60:63], v[164:167]
    s_waitcnt lgkmcnt(0)
    s_barrier
    ds_read_b64_tr_b16 a[158:159], v13 offset:12288
    ds_read_b128 v[80:83], v25 offset:1024
    ds_read_b128 a[124:127], v11 offset:12288
    ds_read_b128 a[128:131], v11 offset:13312
    ds_read_b128 a[132:135], v11 offset:14336
    ds_read_b128 v[48:51], v26 offset:49152
    ds_read_b128 v[52:55], v26 offset:50176
    ds_read_b128 v[56:59], v26 offset:51200
    ds_read_b128 v[60:63], v26 offset:52224
    s_waitcnt lgkmcnt(4)
    v_mfma_f32_16x16x32_bf16 v[112:115], a[230:233], a[124:127], v[112:115]
    ds_read_b64_tr_b16 a[160:161], v12 offset:16384
    ds_read_b64_tr_b16 a[162:163], v12 offset:20480
    ds_read_b64_tr_b16 a[164:165], v13 offset:16384
    v_mfma_f32_16x16x32_bf16 v[132:135], a[228:231], a[124:127], v[132:135]
    s_waitcnt vmcnt(5)
    ds_read_b32 v45, v15 offset:4096
    ds_read_b32 v46, v15 offset:8192
    ds_read_b32 v47, v15 offset:12288
    v_mfma_f32_16x16x32_bf16 v[112:115], a[230:233], a[128:131], v[112:115]
    s_waitcnt lgkmcnt(13)
    v_add_f32 v80, v80, v81
    v_add_f32 v82, v82, v83
    v_mfma_f32_16x16x32_bf16 v[132:135], a[228:231], a[128:131], v[132:135]
    v_add_f32 v80, v80, v82
    v_subrev_u32 v81, 562036736, v80
    ds_read_b64_tr_b16 a[166:167], v13 offset:20480
    v_mfma_f32_16x16x32_bf16 v[112:115], a[230:233], a[132:135], v[112:115]
    s_waitcnt lgkmcnt(1)
    v_max3_u32 v44, v45, v46, v47
    v_cmp_eq_u32 vcc, -1, v44
    s_nop 0
    s_cbranch_vccnz L_refetch0
L_got0:
    v_mfma_f32_16x16x32_bf16 v[132:135], a[228:231], a[132:135], v[132:135]
    v_cmp_lt_u32 vcc, s23, v81
    v_rcp_f32 v80, v80
    s_cbranch_vccnz L_fallback
    s_waitcnt lgkmcnt(7)
    v_mfma_f32_16x16x32_bf16 v[148:151], a[80:83], v[48:51], 0
    ds_read_b64_tr_b16 a[168:169], v12 offset:24576
    ds_read_b64_tr_b16 a[170:171], v12 offset:28672
    ds_read_b64_tr_b16 a[172:173], v13 offset:24576
    s_barrier
    v_mfma_f32_16x16x32_bf16 v[168:171], a[84:87], v[48:51], 0
    ds_read_b128 v[28:31], v14 offset:4096
    ds_read_b128 v[32:35], v14 offset:5120
    ds_read_b64_tr_b16 a[174:175], v13 offset:28672
    v_mfma_f32_16x16x32_bf16 v[148:151], a[88:91], v[52:55], v[148:151]
    ds_read_b128 v[36:39], v14 offset:6144
    ds_read_b128 v[40:43], v14 offset:7168
    v_mfma_f32_16x16x32_bf16 v[168:171], a[92:95], v[52:55], v[168:171]
    ds_read_b128 v[64:67], v14 offset:8192
    ds_read_b128 v[68:71], v14 offset:9216
    v_mul_f32 v112, v80, v112
    v_mfma_f32_16x16x32_bf16 v[148:151], a[96:99], v[56:59], v[148:151]
    ds_read_b128 v[72:75], v14 offset:10240
    ds_read_b128 v[76:79], v14 offset:11264
    v_mul_f32 v113, v80, v113
    v_mfma_f32_16x16x32_bf16 v[168:171], a[100:103], v[56:59], v[168:171]
    v_mul_f32 v114, v80, v114
    v_mul_f32 v115, v80, v115
    v_mfma_f32_16x16x32_bf16 v[148:151], a[104:107], v[60:63], v[148:151]
    v_mul_f32 v132, v80, v132
    v_mul_f32 v133, v80, v133
    v_mfma_f32_16x16x32_bf16 v[168:171], a[108:111], v[60:63], v[168:171]
    v_mul_f32 v134, v80, v134
    v_mul_f32 v135, v80, v135
    s_waitcnt lgkmcnt(4)
    v_mfma_f32_16x16x32_bf16 v[136:139], a[0:3], v[28:31], v[136:139]
    ds_read_b128 v[48:51], v14 offset:12288
    ds_read_b128 v[52:55], v14 offset:13312
    v_cvt_pk_bf16_f32 v192, v112, v113
    v_mfma_f32_16x16x32_bf16 v[156:159], a[4:7], v[28:31], v[156:159]
    ds_read_b128 v[56:59], v14 offset:14336
    ds_read_b128 v[60:63], v14 offset:15360
    v_cvt_pk_bf16_f32 v193, v114, v115
    v_mfma_f32_16x16x32_bf16 v[136:139], a[8:11], v[32:35], v[136:139]
    v_cvt_pk_bf16_f32 v194, v132, v133
    v_cvt_pk_bf16_f32 v195, v134, v135
    v_mfma_f32_16x16x32_bf16 v[156:159], a[12:15], v[32:35], v[156:159]
    v_min_u32 v192, -2, v192
    v_mfma_f32_16x16x32_bf16 v[136:139], a[16:19], v[36:39], v[136:139]
    buffer_store_dwordx4 v[192:195], v26, s[40:43], s48 offen sc1
    v_mfma_f32_16x16x32_bf16 v[156:159], a[20:23], v[36:39], v[156:159]
    ds_write_b128 v19, v[192:195] offset:36864
    v_mfma_f32_16x16x32_bf16 v[136:139], a[24:27], v[40:43], v[136:139]
    s_add_u32 m0, s95, 120832
    s_nop 0
    buffer_load_dwordx4 v26, s[40:43], s9 offen offset:2048 sc1 lds
    s_add_u32 m0, s95, 124928
    s_nop 0
    buffer_load_dwordx4 v26, s[40:43], s10 offen offset:2048 sc1 lds
    v_mfma_f32_16x16x32_bf16 v[156:159], a[28:31], v[40:43], v[156:159]
    s_add_u32 m0, s95, 129024
    s_nop 0
    buffer_load_dwordx4 v26, s[40:43], s11 offen offset:2048 sc1 lds
    s_waitcnt lgkmcnt(5)
    v_mfma_f32_16x16x32_bf16 v[136:139], a[32:35], v[64:67], v[136:139]
    v_mfma_f32_16x16x32_bf16 v[156:159], a[36:39], v[64:67], v[156:159]
    v_mfma_f32_16x16x32_bf16 v[136:139], a[40:43], v[68:71], v[136:139]
    s_waitcnt vmcnt(4)
    ds_read_b32 v45, v15 offset:20480
    ds_read_b32 v46, v15 offset:24576
    ds_read_b32 v47, v15 offset:28672
    v_mfma_f32_16x16x32_bf16 v[156:159], a[44:47], v[68:71], v[156:159]
    v_mfma_f32_16x16x32_bf16 v[136:139], a[48:51], v[72:75], v[136:139]
    v_mfma_f32_16x16x32_bf16 v[156:159], a[52:55], v[72:75], v[156:159]
    s_waitcnt lgkmcnt(0)
    v_max3_u32 v44, v45, v46, v47
    v_cmp_eq_u32 vcc, -1, v44
    s_nop 0
    s_cbranch_vccnz L_refetch1
L_got1:
    v_mfma_f32_16x16x32_bf16 v[136:139], a[56:59], v[76:79], v[136:139]
    v_mfma_f32_16x16x32_bf16 v[156:159], a[60:63], v[76:79], v[156:159]
    s_waitcnt lgkmcnt(4)
    s_barrier
    s_waitcnt lgkmcnt(14)
    v_mfma_f32_16x16x32_bf16 v[136:139], a[144:147], v[48:51], v[136:139]
    ds_read_b128 v[28:31], v14 offset:20480
    ds_read_b128 v[32:35], v14 offset:21504
    v_mfma_f32_16x16x32_bf16 v[156:159], a[148:151], v[48:51], v[156:159]
    ds_read_b128 v[36:39], v14 offset:22528
    ds_read_b128 v[40:43], v14 offset:23552
    v_mfma_f32_16x16x32_bf16 v[136:139], a[152:155], v[52:55], v[136:139]
    ds_read_b128 v[64:67], v14 offset:24576
    ds_read_b128 v[68:71], v14 offset:25600
    v_mfma_f32_16x16x32_bf16 v[156:159], a[156:159], v[52:55], v[156:159]
    ds_read_b128 v[72:75], v14 offset:26624
    ds_read_b128 v[76:79], v14 offset:27648
    v_mfma_f32_16x16x32_bf16 v[136:139], a[160:163], v[56:59], v[136:139]
    v_mfma_f32_16x16x32_bf16 v[156:159], a[164:167], v[56:59], v[156:159]
    v_mfma_f32_16x16x32_bf16 v[136:139], a[168:171], v[60:63], v[136:139]
    v_mfma_f32_16x16x32_bf16 v[156:159], a[172:175], v[60:63], v[156:159]
    s_waitcnt lgkmcnt(4)
    v_mfma_f32_16x16x32_bf16 v[140:143], a[0:3], v[28:31], v[140:143]
    ds_read_b128 v[48:51], v14 offset:28672
    ds_read_b128 v[52:55], v14 offset:29696
    s_and_b32 s54, s20, 1
    v_mfma_f32_16x16x32_bf16 v[160:163], a[4:7], v[28:31], v[160:163]
    ds_read_b128 v[56:59], v14 offset:30720
    ds_read_b128 v[60:63], v14 offset:31744
    s_sub_u32 s56, 3, s54
    v_mfma_f32_16x16x32_bf16 v[140:143], a[8:11], v[32:35], v[140:143]
    s_mul_i32 s54, s54, 3
    s_add_u32 s54, s54, s3
    s_and_b32 s98, s2, 0xf8
    v_mfma_f32_16x16x32_bf16 v[160:163], a[12:15], v[32:35], v[160:163]
    s_mul_i32 s98, s98, 40960
    v_cvt_pk_bf16_f32 v136, v136, v137
    v_cvt_pk_bf16_f32 v137, v138, v139
    v_mfma_f32_16x16x32_bf16 v[140:143], a[16:19], v[36:39], v[140:143]
    s_lshr_b32 s99, s20, 1
    v_cvt_pk_bf16_f32 v138, v156, v157
    v_cvt_pk_bf16_f32 v139, v158, v159
    v_mfma_f32_16x16x32_bf16 v[160:163], a[20:23], v[36:39], v[160:163]
    s_add_u32 m0, s95, 136192
    s_nop 0
    buffer_load_dwordx4 v26, s[40:43], s9 offen offset:3072 sc1 lds
    s_add_u32 m0, s95, 140288
    s_nop 0
    buffer_load_dwordx4 v26, s[40:43], s10 offen offset:3072 sc1 lds
    v_mfma_f32_16x16x32_bf16 v[140:143], a[24:27], v[40:43], v[140:143]
    s_add_u32 m0, s95, 144384
    s_nop 0
    buffer_load_dwordx4 v26, s[40:43], s11 offen offset:3072 sc1 lds
    v_mfma_f32_16x16x32_bf16 v[160:163], a[28:31], v[40:43], v[160:163]
    s_mul_i32 s99, s99, 10240
    v_min_u32 v136, -2, v136
    s_add_u32 s98, s98, s99
    s_waitcnt lgkmcnt(4)
    v_mfma_f32_16x16x32_bf16 v[140:143], a[32:35], v[64:67], v[140:143]
    s_lshl_b32 s99, s54, 10
    s_add_u32 s98, s98, s99
    s_add_u32 s89, s98, 5120
    v_mfma_f32_16x16x32_bf16 v[160:163], a[36:39], v[64:67], v[160:163]
    s_lshl_b32 s54, s54, 4
    s_mul_i32 s98, s21, 80
    s_add_u32 s54, s54, s98
    v_mfma_f32_16x16x32_bf16 v[140:143], a[40:43], v[68:71], v[140:143]
    s_waitcnt vmcnt(3)
    ds_read_b32 v45, v15 offset:36864
    ds_read_b32 v46, v15 offset:40960
    ds_read_b32 v47, v15 offset:45056
    v_mfma_f32_16x16x32_bf16 v[160:163], a[44:47], v[68:71], v[160:163]
    s_lshl_b32 s54, s54, 10
    s_lshl_b32 s98, s22, 8
    s_add_u32 s54, s54, s98
    v_mfma_f32_16x16x32_bf16 v[140:143], a[48:51], v[72:75], v[140:143]
    s_lshr_b32 s98, s20, 1
    s_lshl_b32 s98, s98, 6
    s_add_u32 s54, s54, s98
    v_mfma_f32_16x16x32_bf16 v[160:163], a[52:55], v[72:75], v[160:163]
    s_waitcnt lgkmcnt(0)
    v_max3_u32 v44, v45, v46, v47
    v_cmp_eq_u32 vcc, -1, v44
    s_nop 0
    s_cbranch_vccnz L_refetch2
L_got2:
    v_mfma_f32_16x16x32_bf16 v[140:143], a[56:59], v[76:79], v[140:143]
    v_lshrrev_b32 v1, 3, v4
    v_bfe_u32 v2, v4, 1, 1
    v_mfma_f32_16x16x32_bf16 v[160:163], a[60:63], v[76:79], v[160:163]
    v_lshl_add_u32 v1, v1, 1, v2
    v_bfe_u32 v2, v4, 2, 1
    s_waitcnt lgkmcnt(3)
    s_barrier
    v_mfma_f32_16x16x32_bf16 v[140:143], a[144:147], v[48:51], v[140:143]
    ds_read_b128 v[28:31], v14 offset:36864
    ds_read_b128 v[32:35], v14 offset:37888
    v_lshlrev_b32 v2, 1, v2
    v_mfma_f32_16x16x32_bf16 v[160:163], a[148:151], v[48:51], v[160:163]
    ds_read_b128 v[36:39], v14 offset:38912
    ds_read_b128 v[40:43], v14 offset:39936
    v_xor_b32 v2, v2, v5
    v_mfma_f32_16x16x32_bf16 v[140:143], a[152:155], v[52:55], v[140:143]
    ds_read_b128 v[64:67], v14 offset:40960
    ds_read_b128 v[68:71], v14 offset:41984
    v_lshl_add_u32 v1, v2, 2, v1
    v_mfma_f32_16x16x32_bf16 v[160:163], a[156:159], v[52:55], v[160:163]
    ds_read_b128 v[72:75], v14 offset:43008
    ds_read_b128 v[76:79], v14 offset:44032
    v_and_b32 v2, 1, v4
    v_mfma_f32_16x16x32_bf16 v[140:143], a[160:163], v[56:59], v[140:143]
    v_lshlrev_b32 v2, 4, v2
    v_mov_b32 v3, 0x3f80
    v_mfma_f32_16x16x32_bf16 v[160:163], a[164:167], v[56:59], v[160:163]
    v_lshlrev_b32 v2, v2, v3
    v_mfma_f32_16x16x32_bf16 v[140:143], a[168:171], v[60:63], v[140:143]
    v_cmp_eq_u32 vcc, 0, v1
    s_nop 1
    v_cndmask_b32 v84, 0, v2, vcc
    v_mfma_f32_16x16x32_bf16 v[160:163], a[172:175], v[60:63], v[160:163]
    v_cmp_eq_u32 vcc, 1, v1
    s_nop 1
    v_cndmask_b32 v85, 0, v2, vcc
    s_waitcnt lgkmcnt(4)
    v_mfma_f32_16x16x32_bf16 v[144:147], a[0:3], v[28:31], v[144:147]
    ds_read_b128 v[48:51], v14 offset:45056
    ds_read_b128 v[52:55], v14 offset:46080
    v_mfma_f32_16x16x32_bf16 v[164:167], a[4:7], v[28:31], v[164:167]
    ds_read_b128 v[56:59], v14 offset:47104
    ds_read_b128 v[60:63], v14 offset:48128
    v_mfma_f32_16x16x32_bf16 v[144:147], a[8:11], v[32:35], v[144:147]
    v_cmp_eq_u32 vcc, 2, v1
    s_nop 1
    v_cndmask_b32 v86, 0, v2, vcc
    v_mfma_f32_16x16x32_bf16 v[164:167], a[12:15], v[32:35], v[164:167]
    v_cmp_eq_u32 vcc, 3, v1
    s_nop 1
    v_cndmask_b32 v87, 0, v2, vcc
    v_mfma_f32_16x16x32_bf16 v[144:147], a[16:19], v[36:39], v[144:147]
    v_cmp_eq_u32 vcc, 4, v1
    s_nop 1
    v_cndmask_b32 v88, 0, v2, vcc
    v_mfma_f32_16x16x32_bf16 v[164:167], a[20:23], v[36:39], v[164:167]
    v_cmp_eq_u32 vcc, 5, v1
    s_nop 1
    v_cndmask_b32 v89, 0, v2, vcc
    v_mfma_f32_16x16x32_bf16 v[144:147], a[24:27], v[40:43], v[144:147]
    v_cmp_eq_u32 vcc, 6, v1
    s_nop 1
    v_cndmask_b32 v90, 0, v2, vcc
    v_mfma_f32_16x16x32_bf16 v[164:167], a[28:31], v[40:43], v[164:167]
    v_cmp_eq_u32 vcc, 7, v1
    s_nop 1
    v_cndmask_b32 v91, 0, v2, vcc
    s_waitcnt lgkmcnt(4)
    v_mfma_f32_16x16x32_bf16 v[144:147], a[32:35], v[64:67], v[144:147]
    v_lshrrev_b32 v9, 2, v0
    v_lshlrev_b32 v9, 10, v9
    v_mfma_f32_16x16x32_bf16 v[164:167], a[36:39], v[64:67], v[164:167]
    v_lshl_add_u32 v9, v7, 4, v9
    v_lshlrev_b32 v10, 6, v4
    v_mfma_f32_16x16x32_bf16 v[144:147], a[40:43], v[68:71], v[144:147]
    s_waitcnt vmcnt(0)
    ds_read_b32 v45, v15 offset:53248
    ds_read_b32 v46, v15 offset:57344
    ds_read_b32 v47, v15 offset:61440
    v_mfma_f32_16x16x32_bf16 v[164:167], a[44:47], v[68:71], v[164:167]
    v_lshl_add_u32 v10, v5, 4, v10
    v_add_u32 v10, s95, v10
    s_mov_b32 s32, s14
    v_mfma_f32_16x16x32_bf16 v[144:147], a[48:51], v[72:75], v[144:147]
    s_mov_b32 s33, s15
    s_mov_b32 s34, 655360
    s_mov_b32 s35, 0x20000
    v_mfma_f32_16x16x32_bf16 v[164:167], a[52:55], v[72:75], v[164:167]
    s_add_u32 m0, s95, 90112
    s_add_u32 s57, s9, 4096
    buffer_load_dwordx4 v26, s[40:43], s57 offen sc1 lds
    s_add_u32 m0, s95, 94208
    s_add_u32 s57, s10, 4096
    buffer_load_dwordx4 v26, s[40:43], s57 offen sc1 lds
    v_mfma_f32_16x16x32_bf16 v[144:147], a[56:59], v[76:79], v[144:147]
    s_add_u32 m0, s95, 98304
    s_add_u32 s57, s11, 4096
    buffer_load_dwordx4 v26, s[40:43], s57 offen sc1 lds
    s_mov_b64 exec, 16711680
    buffer_load_dword v18, v17, s[24:27], 0 offen sc1
    s_mov_b64 exec, -1
    v_mfma_f32_16x16x32_bf16 v[164:167], a[60:63], v[76:79], v[164:167]
    s_waitcnt lgkmcnt(0)
    v_max3_u32 v44, v45, v46, v47
    v_cmp_eq_u32 vcc, -1, v44
    s_nop 0
    s_cbranch_vccnz L_refetch3
L_got3:
    s_waitcnt lgkmcnt(3)
    s_barrier
    v_mfma_f32_16x16x32_bf16 v[144:147], a[144:147], v[48:51], v[144:147]
    ds_read_b128 v[28:31], v14 offset:53248
    ds_read_b128 v[32:35], v14 offset:54272
    v_mfma_f32_16x16x32_bf16 v[164:167], a[148:151], v[48:51], v[164:167]
    ds_read_b128 v[36:39], v14 offset:55296
    ds_read_b128 v[40:43], v14 offset:56320
    v_mfma_f32_16x16x32_bf16 v[144:147], a[152:155], v[52:55], v[144:147]
    ds_read_b128 v[64:67], v14 offset:57344
    ds_read_b128 v[68:71], v14 offset:58368
    v_mfma_f32_16x16x32_bf16 v[164:167], a[156:159], v[52:55], v[164:167]
    ds_read_b128 v[72:75], v14 offset:59392
    ds_read_b128 v[76:79], v14 offset:60416
    v_mfma_f32_16x16x32_bf16 v[144:147], a[160:163], v[56:59], v[144:147]
    buffer_store_dwordx4 v[136:139], v26, s[64:67], s49 offen offset:0 sc1
    v_mfma_f32_16x16x32_bf16 v[164:167], a[164:167], v[56:59], v[164:167]
    v_cvt_pk_bf16_f32 v140, v140, v141
    v_cvt_pk_bf16_f32 v141, v142, v143
    v_mfma_f32_16x16x32_bf16 v[144:147], a[168:171], v[60:63], v[144:147]
    v_cvt_pk_bf16_f32 v142, v160, v161
    v_cvt_pk_bf16_f32 v143, v162, v163
    v_mfma_f32_16x16x32_bf16 v[164:167], a[172:175], v[60:63], v[164:167]
    v_min_u32 v140, -2, v140
    s_waitcnt lgkmcnt(4)
    v_mfma_f32_16x16x32_bf16 v[148:151], a[0:3], v[28:31], v[148:151]
    ds_read_b128 v[48:51], v14 offset:61440
    ds_read_b128 v[52:55], v14 offset:62464
    v_mfma_f32_16x16x32_bf16 v[168:171], a[4:7], v[28:31], v[168:171]
    ds_read_b128 v[56:59], v14 offset:63488
    ds_read_b128 v[60:63], v14 offset:64512
    v_mfma_f32_16x16x32_bf16 v[148:151], a[8:11], v[32:35], v[148:151]
    buffer_store_dwordx4 v[140:143], v26, s[64:67], s49 offen offset:1024 sc1
    v_mfma_f32_16x16x32_bf16 v[168:171], a[12:15], v[32:35], v[168:171]
    v_cvt_pk_bf16_f32 v144, v144, v145
    v_cvt_pk_bf16_f32 v145, v146, v147
    v_mfma_f32_16x16x32_bf16 v[148:151], a[16:19], v[36:39], v[148:151]
    v_cvt_pk_bf16_f32 v146, v164, v165
    v_cvt_pk_bf16_f32 v147, v166, v167
    v_mfma_f32_16x16x32_bf16 v[168:171], a[20:23], v[36:39], v[168:171]
    v_min_u32 v144, -2, v144
    v_mfma_f32_16x16x32_bf16 v[148:151], a[24:27], v[40:43], v[148:151]
    buffer_store_dwordx4 v[144:147], v26, s[64:67], s49 offen offset:2048 sc1
    v_mfma_f32_16x16x32_bf16 v[168:171], a[28:31], v[40:43], v[168:171]
    s_waitcnt lgkmcnt(4)
    v_mfma_f32_16x16x32_bf16 v[148:151], a[32:35], v[64:67], v[148:151]
    v_mfma_f32_16x16x32_bf16 v[168:171], a[36:39], v[64:67], v[168:171]
    v_mfma_f32_16x16x32_bf16 v[148:151], a[40:43], v[68:71], v[148:151]
    s_waitcnt vmcnt(4)
    ds_read_b32 v45, v15 offset:4096
    ds_read_b32 v46, v15 offset:8192
    ds_read_b32 v47, v15 offset:12288
    v_mfma_f32_16x16x32_bf16 v[168:171], a[44:47], v[68:71], v[168:171]
    v_mfma_f32_16x16x32_bf16 v[148:151], a[48:51], v[72:75], v[148:151]
    v_mfma_f32_16x16x32_bf16 v[168:171], a[52:55], v[72:75], v[168:171]
    s_waitcnt lgkmcnt(0)
    v_max3_u32 v44, v45, v46, v47
    v_cmp_eq_u32 vcc, -1, v44
    s_nop 0
    s_cbranch_vccnz L_refetch4
L_got4:
    v_mfma_f32_16x16x32_bf16 v[148:151], a[56:59], v[76:79], v[148:151]
    v_mfma_f32_16x16x32_bf16 v[168:171], a[60:63], v[76:79], v[168:171]
    s_waitcnt lgkmcnt(3)
    s_barrier
    v_mfma_f32_16x16x32_bf16 v[148:151], a[144:147], v[48:51], v[148:151]
    ds_read_b128 v[28:31], v26 offset:36864
    ds_read_b128 v[32:35], v26 offset:37888
    v_mfma_f32_16x16x32_bf16 v[168:171], a[148:151], v[48:51], v[168:171]
    ds_read_b128 v[36:39], v26 offset:38912
    ds_read_b128 v[40:43], v26 offset:39936
    v_mfma_f32_16x16x32_bf16 v[148:151], a[152:155], v[52:55], v[148:151]
    ds_read_b128 v[64:67], v14 offset:4096
    ds_read_b128 v[68:71], v14 offset:5120
    v_mfma_f32_16x16x32_bf16 v[168:171], a[156:159], v[52:55], v[168:171]
    ds_read_b128 v[72:75], v14 offset:6144
    ds_read_b128 v[76:79], v14 offset:7168
    v_mfma_f32_16x16x32_bf16 v[148:151], a[160:163], v[56:59], v[148:151]
    v_mfma_f32_16x16x32_bf16 v[168:171], a[164:167], v[56:59], v[168:171]
    v_mfma_f32_16x16x32_bf16 v[148:151], a[168:171], v[60:63], v[148:151]
    v_mfma_f32_16x16x32_bf16 v[168:171], a[172:175], v[60:63], v[168:171]
    s_waitcnt lgkmcnt(4)
    v_mfma_f32_16x16x32_bf16 v[152:155], a[80:83], v[28:31], 0
    ds_read_b128 v[48:51], v14 offset:8192
    ds_read_b128 v[52:55], v14 offset:9216
    v_mfma_f32_16x16x32_bf16 v[172:175], a[84:87], v[28:31], 0
    ds_read_b128 v[56:59], v14 offset:10240
    ds_read_b128 v[60:63], v14 offset:11264
    v_mfma_f32_16x16x32_bf16 v[152:155], a[88:91], v[32:35], v[152:155]
    v_mfma_f32_16x16x32_bf16 v[172:175], a[92:95], v[32:35], v[172:175]
    v_cvt_pk_bf16_f32 v148, v148, v149
    v_cvt_pk_bf16_f32 v149, v150, v151
    v_mfma_f32_16x16x32_bf16 v[152:155], a[96:99], v[36:39], v[152:155]
    v_cvt_pk_bf16_f32 v150, v168, v169
    v_cvt_pk_bf16_f32 v151, v170, v171
    v_mfma_f32_16x16x32_bf16 v[172:175], a[100:103], v[36:39], v[172:175]
    v_min_u32 v148, -2, v148
    v_mfma_f32_16x16x32_bf16 v[152:155], a[104:107], v[40:43], v[152:155]
    buffer_store_dwordx4 v[148:151], v26, s[64:67], s49 offen offset:3072 sc1
    v_mfma_f32_16x16x32_bf16 v[172:175], a[108:111], v[40:43], v[172:175]
    s_waitcnt lgkmcnt(4)
    v_mfma_f32_16x16x32_bf16 v[152:155], a[0:3], v[64:67], v[152:155]
    ds_read_b128 v[28:31], v14 offset:12288
    ds_read_b128 v[32:35], v14 offset:13312
    v_mfma_f32_16x16x32_bf16 v[172:175], a[4:7], v[64:67], v[172:175]
    ds_read_b128 v[36:39], v14 offset:14336
    ds_read_b128 v[40:43], v14 offset:15360
    v_mfma_f32_16x16x32_bf16 v[152:155], a[8:11], v[68:71], v[152:155]
    v_mfma_f32_16x16x32_bf16 v[172:175], a[12:15], v[68:71], v[172:175]
    v_mfma_f32_16x16x32_bf16 v[152:155], a[16:19], v[72:75], v[152:155]
    v_mfma_f32_16x16x32_bf16 v[172:175], a[20:23], v[72:75], v[172:175]
    v_mfma_f32_16x16x32_bf16 v[152:155], a[24:27], v[76:79], v[152:155]
    v_mfma_f32_16x16x32_bf16 v[172:175], a[28:31], v[76:79], v[172:175]
    s_waitcnt lgkmcnt(4)
    v_mfma_f32_16x16x32_bf16 v[152:155], a[32:35], v[48:51], v[152:155]
    v_mfma_f32_16x16x32_bf16 v[172:175], a[36:39], v[48:51], v[172:175]
    v_mfma_f32_16x16x32_bf16 v[152:155], a[40:43], v[52:55], v[152:155]
    v_mfma_f32_16x16x32_bf16 v[172:175], a[44:47], v[52:55], v[172:175]
    v_mfma_f32_16x16x32_bf16 v[152:155], a[48:51], v[56:59], v[152:155]
    v_mfma_f32_16x16x32_bf16 v[172:175], a[52:55], v[56:59], v[172:175]
    v_mfma_f32_16x16x32_bf16 v[152:155], a[56:59], v[60:63], v[152:155]
    v_mfma_f32_16x16x32_bf16 v[172:175], a[60:63], v[60:63], v[172:175]
    s_waitcnt lgkmcnt(0)
    v_mfma_f32_16x16x32_bf16 v[152:155], a[144:147], v[28:31], v[152:155]
    v_mfma_f32_16x16x32_bf16 v[172:175], a[148:151], v[28:31], v[172:175]
    v_mfma_f32_16x16x32_bf16 v[152:155], a[152:155], v[32:35], v[152:155]
    v_mfma_f32_16x16x32_bf16 v[172:175], a[156:159], v[32:35], v[172:175]
    v_mfma_f32_16x16x32_bf16 v[152:155], a[160:163], v[36:39], v[152:155]
    v_mfma_f32_16x16x32_bf16 v[172:175], a[164:167], v[36:39], v[172:175]
    v_mfma_f32_16x16x32_bf16 v[152:155], a[168:171], v[40:43], v[152:155]
    v_mfma_f32_16x16x32_bf16 v[172:175], a[172:175], v[40:43], v[172:175]
    s_nop 6
    v_cvt_pk_bf16_f32 v152, v152, v153
    v_cvt_pk_bf16_f32 v153, v154, v155
    v_cvt_pk_bf16_f32 v154, v172, v173
    v_cvt_pk_bf16_f32 v155, v174, v175
    v_min_u32 v152, -2, v152
    buffer_store_dwordx4 v[152:155], v26, s[64:67], s51 offen offset:0 sc1
    s_cmp_ge_u32 s3, s56
    s_cbranch_scc1 L_fin
    s_waitcnt vmcnt(5)
    v_cmp_eq_u32 vcc, -1, v18
    s_nop 0
    s_and_b32 s58, vcc_lo, 16711680
    s_cbranch_scc1 L_waitp
L_pok:
    s_mov_b32 s55, s89
    buffer_load_dwordx4 v[196:199], v26, s[24:27], s55 offen sc1
    s_add_u32 s55, s55, 40960
    buffer_load_dwordx4 v[200:203], v26, s[24:27], s55 offen sc1
    s_add_u32 s55, s55, 40960
    buffer_load_dwordx4 v[204:207], v26, s[24:27], s55 offen sc1
    s_add_u32 s55, s55, 40960
    buffer_load_dwordx4 v[208:211], v26, s[24:27], s55 offen sc1
    s_add_u32 s55, s55, 40960
    buffer_load_dwordx4 v[212:215], v26, s[24:27], s55 offen sc1
    s_add_u32 s55, s55, 40960
    buffer_load_dwordx4 v[216:219], v26, s[24:27], s55 offen sc1
    s_add_u32 s55, s55, 40960
    buffer_load_dwordx4 v[220:223], v26, s[24:27], s55 offen sc1
    s_add_u32 s55, s55, 40960
    buffer_load_dwordx4 v[224:227], v26, s[24:27], s55 offen sc1
L_red:
    v_mov_b32 v16, 0
    s_waitcnt vmcnt(7)
    v_mfma_f32_16x16x32_bf16 v[48:51], v[84:87], v[196:199], 0
    v_max_u32 v16, v16, v196
    v_mfma_f32_16x16x32_bf16 v[52:55], v[88:91], v[196:199], 0
    s_waitcnt vmcnt(6)
    v_mfma_f32_16x16x32_bf16 v[48:51], v[84:87], v[200:203], v[48:51]
    v_max_u32 v16, v16, v200
    v_mfma_f32_16x16x32_bf16 v[52:55], v[88:91], v[200:203], v[52:55]
    s_waitcnt vmcnt(5)
    v_mfma_f32_16x16x32_bf16 v[48:51], v[84:87], v[204:207], v[48:51]
    v_max_u32 v16, v16, v204
    v_mfma_f32_16x16x32_bf16 v[52:55], v[88:91], v[204:207], v[52:55]
    s_waitcnt vmcnt(4)
    v_mfma_f32_16x16x32_bf16 v[48:51], v[84:87], v[208:211], v[48:51]
    v_max_u32 v16, v16, v208
    v_mfma_f32_16x16x32_bf16 v[52:55], v[88:91], v[208:211], v[52:55]
    s_waitcnt vmcnt(3)
    v_mfma_f32_16x16x32_bf16 v[48:51], v[84:87], v[212:215], v[48:51]
    v_max_u32 v16, v16, v212
    v_mfma_f32_16x16x32_bf16 v[52:55], v[88:91], v[212:215], v[52:55]
    s_waitcnt vmcnt(2)
    v_mfma_f32_16x16x32_bf16 v[48:51], v[84:87], v[216:219], v[48:51]
    v_max_u32 v16, v16, v216
    v_mfma_f32_16x16x32_bf16 v[52:55], v[88:91], v[216:219], v[52:55]
    s_waitcnt vmcnt(1)
    v_mfma_f32_16x16x32_bf16 v[48:51], v[84:87], v[220:223], v[48:51]
    v_max_u32 v16, v16, v220
    v_mfma_f32_16x16x32_bf16 v[52:55], v[88:91], v[220:223], v[52:55]
    s_waitcnt vmcnt(0)
    v_mfma_f32_16x16x32_bf16 v[48:51], v[84:87], v[224:227], v[48:51]
    v_max_u32 v16, v16, v224
    v_mfma_f32_16x16x32_bf16 v[52:55], v[88:91], v[224:227], v[52:55]
    v_cmp_eq_u32 vcc, -1, v16
    s_nop 4
    s_cbranch_vccnz L_redo
L_redok:
    s_nop 0
    v_cvt_pk_bf16_f32 v48, v48, v49
    v_cvt_pk_bf16_f32 v49, v50, v51
    v_cvt_pk_bf16_f32 v50, v52, v53
    v_cvt_pk_bf16_f32 v51, v54, v55
    ds_write_b128 v10, v[48:51]
    s_waitcnt lgkmcnt(0)
    ds_read_b128 v[48:51], v19
    s_waitcnt lgkmcnt(0)
    buffer_store_dwordx4 v[48:51], v9, s[32:35], s54 offen sc1
L_fin:
L_done:
    s_endpgm
L_redo:
    s_add_u32 s62, s62, 1
    s_cmp_ge_u32 s62, 400000
    s_cbranch_scc1 L_redok
    s_mov_b32 s55, s89
    buffer_load_dwordx4 v[196:199], v26, s[24:27], s55 offen sc1
    s_add_u32 s55, s55, 40960
    buffer_load_dwordx4 v[200:203], v26, s[24:27], s55 offen sc1
    s_add_u32 s55, s55, 40960
    buffer_load_dwordx4 v[204:207], v26, s[24:27], s55 offen sc1
    s_add_u32 s55, s55, 40960
    buffer_load_dwordx4 v[208:211], v26, s[24:27], s55 offen sc1
    s_add_u32 s55, s55, 40960
    buffer_load_dwordx4 v[212:215], v26, s[24:27], s55 offen sc1
    s_add_u32 s55, s55, 40960
    buffer_load_dwordx4 v[216:219], v26, s[24:27], s55 offen sc1
    s_add_u32 s55, s55, 40960
    buffer_load_dwordx4 v[220:223], v26, s[24:27], s55 offen sc1
    s_add_u32 s55, s55, 40960
    buffer_load_dwordx4 v[224:227], v26, s[24:27], s55 offen sc1
    s_branch L_red
L_hs:
    v_mov_b32 v2, 0
    s_sleep 4
    buffer_load_dword v27, v2, s[28:31], s55 offen sc1
    s_waitcnt vmcnt(0)
    s_add_u32 s62, s62, 1
    s_cmp_ge_u32 s62, 400000
    s_cbranch_scc1 L_hsok
    v_readfirstlane_b32 s58, v27
    s_nop 0
    s_cmp_ge_u32 s58, 32
    s_cbranch_scc0 L_hs
    s_branch L_hsok
L_waitf:
    s_sleep 2
    s_mov_b64 exec, 15
    buffer_load_dword v18, v17, s[24:27], 0 offen sc1
    s_mov_b64 exec, -1
    s_waitcnt vmcnt(0)
    s_add_u32 s62, s62, 1
    s_cmp_ge_u32 s62, 400000
    s_cbranch_scc1 L_fok
    v_cmp_eq_u32 vcc, -1, v18
    s_nop 0
    s_and_b32 s58, vcc_lo, 15
    s_cbranch_scc1 L_waitf
    s_branch L_fok
L_waitp:
    s_sleep 2
    s_mov_b64 exec, 16711680
    buffer_load_dword v18, v17, s[24:27], 0 offen sc1
    s_mov_b64 exec, -1
    s_waitcnt vmcnt(0)
    s_add_u32 s62, s62, 1
    s_cmp_ge_u32 s62, 400000
    s_cbranch_scc1 L_pok
    v_cmp_eq_u32 vcc, -1, v18
    s_nop 0
    s_and_b32 s58, vcc_lo, 16711680
    s_cbranch_scc1 L_waitp
    s_branch L_pok
L_refetch0:
    s_add_u32 s62, s62, 1
    s_cmp_ge_u32 s62, 400000
    s_cbranch_scc1 L_got0
    s_add_u32 m0, s95, 90112
    s_nop 0
    buffer_load_dwordx4 v26, s[40:43], s9 offen offset:0 sc1 lds
    s_add_u32 m0, s95, 94208
    s_nop 0
    buffer_load_dwordx4 v26, s[40:43], s10 offen offset:0 sc1 lds
    s_add_u32 m0, s95, 98304
    s_nop 0
    buffer_load_dwordx4 v26, s[40:43], s11 offen offset:0 sc1 lds
    s_waitcnt vmcnt(0)
    ds_read_b32 v45, v15 offset:4096
    ds_read_b32 v46, v15 offset:8192
    ds_read_b32 v47, v15 offset:12288
    s_waitcnt lgkmcnt(0)
    v_max3_u32 v44, v45, v46, v47
    v_cmp_eq_u32 vcc, -1, v44
    s_nop 1
    s_cbranch_vccnz L_refetch0
    s_branch L_got0
L_refetch1:
    s_add_u32 s62, s62, 1
    s_cmp_ge_u32 s62, 400000
    s_cbranch_scc1 L_got1
    s_add_u32 m0, s95, 105472
    s_nop 0
    buffer_load_dwordx4 v26, s[40:43], s9 offen offset:1024 sc1 lds
    s_add_u32 m0, s95, 109568
    s_nop 0
    buffer_load_dwordx4 v26, s[40:43], s10 offen offset:1024 sc1 lds
    s_add_u32 m0, s95, 113664
    s_nop 0
    buffer_load_dwordx4 v26, s[40:43], s11 offen offset:1024 sc1 lds
    s_waitcnt vmcnt(0)
    ds_read_b32 v45, v15 offset:20480
    ds_read_b32 v46, v15 offset:24576
    ds_read_b32 v47, v15 offset:28672
    s_waitcnt lgkmcnt(0)
    v_max3_u32 v44, v45, v46, v47
    v_cmp_eq_u32 vcc, -1, v44
    s_nop 1
    s_cbranch_vccnz L_refetch1
    s_branch L_got1
L_refetch2:
    s_add_u32 s62, s62, 1
    s_cmp_ge_u32 s62, 400000
    s_cbranch_scc1 L_got2
    s_add_u32 m0, s95, 120832
    s_nop 0
    buffer_load_dwordx4 v26, s[40:43], s9 offen offset:2048 sc1 lds
    s_add_u32 m0, s95, 124928
    s_nop 0
    buffer_load_dwordx4 v26, s[40:43], s10 offen offset:2048 sc1 lds
    s_add_u32 m0, s95, 129024
    s_nop 0
    buffer_load_dwordx4 v26, s[40:43], s11 offen offset:2048 sc1 lds
    s_waitcnt vmcnt(0)
    ds_read_b32 v45, v15 offset:36864
    ds_read_b32 v46, v15 offset:40960
    ds_read_b32 v47, v15 offset:45056
    s_waitcnt lgkmcnt(0)
    v_max3_u32 v44, v45, v46, v47
    v_cmp_eq_u32 vcc, -1, v44
    s_nop 1
    s_cbranch_vccnz L_refetch2
    s_branch L_got2
L_refetch3:
    s_add_u32 s62, s62, 1
    s_cmp_ge_u32 s62, 400000
    s_cbranch_scc1 L_got3
    s_add_u32 m0, s95, 136192
    s_nop 0
    buffer_load_dwordx4 v26, s[40:43], s9 offen offset:3072 sc1 lds
    s_add_u32 m0, s95, 140288
    s_nop 0
    buffer_load_dwordx4 v26, s[40:43], s10 offen offset:3072 sc1 lds
    s_add_u32 m0, s95, 144384
    s_nop 0
    buffer_load_dwordx4 v26, s[40:43], s11 offen offset:3072 sc1 lds
    s_waitcnt vmcnt(0)
    ds_read_b32 v45, v15 offset:53248
    ds_read_b32 v46, v15 offset:57344
    ds_read_b32 v47, v15 offset:61440
    s_waitcnt lgkmcnt(0)
    v_max3_u32 v44, v45, v46, v47
    v_cmp_eq_u32 vcc, -1, v44
    s_nop 1
    s_cbranch_vccnz L_refetch3
    s_branch L_got3
L_refetch4:
    s_add_u32 s62, s62, 1
    s_cmp_ge_u32 s62, 400000
    s_cbranch_scc1 L_got4
    s_add_u32 m0, s95, 90112
    s_add_u32 s57, s9, 4096
    buffer_load_dwordx4 v26, s[40:43], s57 offen sc1 lds
    s_add_u32 m0, s95, 94208
    s_add_u32 s57, s10, 4096
    buffer_load_dwordx4 v26, s[40:43], s57 offen sc1 lds
    s_add_u32 m0, s95, 98304
    s_add_u32 s57, s11, 4096
    buffer_load_dwordx4 v26, s[40:43], s57 offen sc1 lds
    s_waitcnt vmcnt(0)
    ds_read_b32 v45, v15 offset:4096
    ds_read_b32 v46, v15 offset:8192
    ds_read_b32 v47, v15 offset:12288
    s_waitcnt lgkmcnt(0)
    v_max3_u32 v44, v45, v46, v47
    v_cmp_eq_u32 vcc, -1, v44
    s_nop 1
    s_cbranch_vccnz L_refetch4
    s_branch L_got4
L_fallback:
    s_waitcnt vmcnt(0) lgkmcnt(0)
    s_barrier
    s_mov_b32 s23, -1
    s_load_dwordx16 s[4:19], s[0:1], 0
    s_branch L_restart
L_rowmax:
    s_waitcnt vmcnt(0) lgkmcnt(0)
    ds_read_b128 a[16:19], v90 offset:4096
    ds_read_b128 a[20:23], v91 offset:4096
    ds_read_b128 a[24:27], v92 offset:4096
    ds_read_b128 a[28:31], v93 offset:4096
    ds_read_b128 a[32:35], v90 offset:8192
    ds_read_b128 a[36:39], v91 offset:8192
    ds_read_b128 a[40:43], v92 offset:8192
    ds_read_b128 a[44:47], v93 offset:8192
    s_waitcnt lgkmcnt(0)
    ds_read_b128 a[48:51], v90 offset:12288
    ds_read_b128 a[52:55], v91 offset:12288
    ds_read_b128 a[56:59], v92 offset:12288
    ds_read_b128 a[60:63], v93 offset:12288
    ds_read_b128 a[64:67], v90 offset:16384
    ds_read_b128 a[68:71], v91 offset:16384
    ds_read_b128 a[72:75], v92 offset:16384
    ds_read_b128 a[76:79], v93 offset:16384
    v_subrev_u32 v28, 53248, v8
    v_subrev_u32 v29, 53248, v9
    v_subrev_u32 v30, 53248, v10
    v_subrev_u32 v31, 53248, v11
    v_mov_b32 v32, 0xff800000
    v_mov_b32 v33, 0xff800000
    v_mov_b32 v34, 0xff800000
    v_mov_b32 v35, 0xff800000
    v_mov_b32 v36, 0xff800000
    s_mov_b32 s48, 0
    s_mov_b32 s49, 4096
L_fbmax:
    s_add_u32 m0, s52, 0
    s_nop 0
    buffer_load_dwordx4 v20, s[32:35], s48 offen offset:0 lds
    buffer_load_dwordx4 v20, s[32:35], s48 offen offset:1024 lds
    buffer_load_dwordx4 v21, s[32:35], s48 offen offset:2048 lds
    buffer_load_dwordx4 v21, s[32:35], s48 offen offset:3072 lds
    s_add_u32 m0, s52, 4096
    s_nop 0
    buffer_load_dwordx4 v22, s[32:35], s49 offen offset:0 lds
    buffer_load_dwordx4 v22, s[32:35], s49 offen offset:1024 lds
    buffer_load_dwordx4 v23, s[32:35], s49 offen offset:2048 lds
    buffer_load_dwordx4 v23, s[32:35], s49 offen offset:3072 lds
    s_waitcnt vmcnt(0)
    ds_read_b128 a[112:115], v28 offset:0
    ds_read_b128 a[116:119], v29 offset:0
    ds_read_b128 a[120:123], v30 offset:0
    ds_read_b128 a[124:127], v31 offset:0
    ds_read_b128 a[128:131], v28 offset:1024
    ds_read_b128 a[132:135], v29 offset:1024
    ds_read_b128 a[136:139], v30 offset:1024
    ds_read_b128 a[140:143], v31 offset:1024
    s_waitcnt lgkmcnt(0)
    v_mfma_f32_16x16x32_bf16 v[48:51], a[112:115], a[0:3], 0
    v_mfma_f32_16x16x32_bf16 v[48:51], a[116:119], a[4:7], v[48:51]
    v_mfma_f32_16x16x32_bf16 v[48:51], a[120:123], a[8:11], v[48:51]
    v_mfma_f32_16x16x32_bf16 v[48:51], a[124:127], a[12:15], v[48:51]
    v_mfma_f32_16x16x32_bf16 v[52:55], a[128:131], a[0:3], 0
    v_mfma_f32_16x16x32_bf16 v[52:55], a[132:135], a[4:7], v[52:55]
    v_mfma_f32_16x16x32_bf16 v[52:55], a[136:139], a[8:11], v[52:55]
    v_mfma_f32_16x16x32_bf16 v[52:55], a[140:143], a[12:15], v[52:55]
    s_nop 7
    v_max3_f32 v32, v32, v48, v49
    v_max3_f32 v32, v32, v50, v51
    v_max3_f32 v32, v32, v52, v53
    v_max3_f32 v32, v32, v54, v55
    v_mfma_f32_16x16x32_bf16 v[48:51], a[112:115], a[16:19], 0
    v_mfma_f32_16x16x32_bf16 v[48:51], a[116:119], a[20:23], v[48:51]
    v_mfma_f32_16x16x32_bf16 v[48:51], a[120:123], a[24:27], v[48:51]
    v_mfma_f32_16x16x32_bf16 v[48:51], a[124:127], a[28:31], v[48:51]
    v_mfma_f32_16x16x32_bf16 v[52:55], a[128:131], a[16:19], 0
    v_mfma_f32_16x16x32_bf16 v[52:55], a[132:135], a[20:23], v[52:55]
    v_mfma_f32_16x16x32_bf16 v[52:55], a[136:139], a[24:27], v[52:55]
    v_mfma_f32_16x16x32_bf16 v[52:55], a[140:143], a[28:31], v[52:55]
    s_nop 7
    v_max3_f32 v33, v33, v48, v49
    v_max3_f32 v33, v33, v50, v51
    v_max3_f32 v33, v33, v52, v53
    v_max3_f32 v33, v33, v54, v55
    v_mfma_f32_16x16x32_bf16 v[48:51], a[112:115], a[32:35], 0
    v_mfma_f32_16x16x32_bf16 v[48:51], a[116:119], a[36:39], v[48:51]
    v_mfma_f32_16x16x32_bf16 v[48:51], a[120:123], a[40:43], v[48:51]
    v_mfma_f32_16x16x32_bf16 v[48:51], a[124:127], a[44:47], v[48:51]
    v_mfma_f32_16x16x32_bf16 v[52:55], a[128:131], a[32:35], 0
    v_mfma_f32_16x16x32_bf16 v[52:55], a[132:135], a[36:39], v[52:55]
    v_mfma_f32_16x16x32_bf16 v[52:55], a[136:139], a[40:43], v[52:55]
    v_mfma_f32_16x16x32_bf16 v[52:55], a[140:143], a[44:47], v[52:55]
    s_nop 7
    v_max3_f32 v34, v34, v48, v49
    v_max3_f32 v34, v34, v50, v51
    v_max3_f32 v34, v34, v52, v53
    v_max3_f32 v34, v34, v54, v55
    v_mfma_f32_16x16x32_bf16 v[48:51], a[112:115], a[48:51], 0
    v_mfma_f32_16x16x32_bf16 v[48:51], a[116:119], a[52:55], v[48:51]
    v_mfma_f32_16x16x32_bf16 v[48:51], a[120:123], a[56:59], v[48:51]
    v_mfma_f32_16x16x32_bf16 v[48:51], a[124:127], a[60:63], v[48:51]
    v_mfma_f32_16x16x32_bf16 v[52:55], a[128:131], a[48:51], 0
    v_mfma_f32_16x16x32_bf16 v[52:55], a[132:135], a[52:55], v[52:55]
    v_mfma_f32_16x16x32_bf16 v[52:55], a[136:139], a[56:59], v[52:55]
    v_mfma_f32_16x16x32_bf16 v[52:55], a[140:143], a[60:63], v[52:55]
    s_nop 7
    v_max3_f32 v35, v35, v48, v49
    v_max3_f32 v35, v35, v50, v51
    v_max3_f32 v35, v35, v52, v53
    v_max3_f32 v35, v35, v54, v55
    v_mfma_f32_16x16x32_bf16 v[48:51], a[112:115], a[64:67], 0
    v_mfma_f32_16x16x32_bf16 v[48:51], a[116:119], a[68:71], v[48:51]
    v_mfma_f32_16x16x32_bf16 v[48:51], a[120:123], a[72:75], v[48:51]
    v_mfma_f32_16x16x32_bf16 v[48:51], a[124:127], a[76:79], v[48:51]
    v_mfma_f32_16x16x32_bf16 v[52:55], a[128:131], a[64:67], 0
    v_mfma_f32_16x16x32_bf16 v[52:55], a[132:135], a[68:71], v[52:55]
    v_mfma_f32_16x16x32_bf16 v[52:55], a[136:139], a[72:75], v[52:55]
    v_mfma_f32_16x16x32_bf16 v[52:55], a[140:143], a[76:79], v[52:55]
    s_nop 7
    v_max3_f32 v36, v36, v48, v49
    v_max3_f32 v36, v36, v50, v51
    v_max3_f32 v36, v36, v52, v53
    v_max3_f32 v36, v36, v54, v55
    s_add_u32 s48, s48, 8192
    s_add_u32 s49, s49, 8192
    s_cmp_lt_u32 s48, 65536
    s_cbranch_scc1 L_fbmax
    v_mov_b32 v1, v32
    s_nop 1
    v_permlane32_swap_b32 v32, v1
    s_nop 1
    v_max_f32 v32, v32, v1
    v_mov_b32 v1, v32
    s_nop 1
    v_permlane16_swap_b32 v32, v1
    s_nop 1
    v_max_f32 v32, v32, v1
    v_mov_b32 v1, v33
    s_nop 1
    v_permlane32_swap_b32 v33, v1
    s_nop 1
    v_max_f32 v33, v33, v1
    v_mov_b32 v1, v33
    s_nop 1
    v_permlane16_swap_b32 v33, v1
    s_nop 1
    v_max_f32 v33, v33, v1
    v_mov_b32 v1, v34
    s_nop 1
    v_permlane32_swap_b32 v34, v1
    s_nop 1
    v_max_f32 v34, v34, v1
    v_mov_b32 v1, v34
    s_nop 1
    v_permlane16_swap_b32 v34, v1
    s_nop 1
    v_max_f32 v34, v34, v1
    v_mov_b32 v1, v35
    s_nop 1
    v_permlane32_swap_b32 v35, v1
    s_nop 1
    v_max_f32 v35, v35, v1
    v_mov_b32 v1, v35
    s_nop 1
    v_permlane16_swap_b32 v35, v1
    s_nop 1
    v_max_f32 v35, v35, v1
    v_mov_b32 v1, v36
    s_nop 1
    v_permlane32_swap_b32 v36, v1
    s_nop 1
    v_max_f32 v36, v36, v1
    v_mov_b32 v1, v36
    s_nop 1
    v_permlane16_swap_b32 v36, v1
    s_nop 1
    v_max_f32 v36, v36, v1
    v_accvgpr_read_b32 v1, a239
    v_accvgpr_read_b32 v2, a240
    ds_write_b32 v1, v32 offset:0
    ds_write_b32 v1, v33 offset:256
    ds_write_b32 v1, v34 offset:512
    ds_write_b32 v1, v35 offset:768
    ds_write_b32 v1, v36 offset:1024
    s_waitcnt lgkmcnt(0)
    s_barrier
    ds_read_b128 v[64:67], v2 offset:0
    ds_read_b128 v[68:71], v2 offset:256
    ds_read_b128 v[72:75], v2 offset:512
    ds_read_b128 v[76:79], v2 offset:768
    ds_read_b128 v[80:83], v2 offset:1024
    s_waitcnt lgkmcnt(0)
    v_max3_f32 v64, v64, v65, v66
    v_max_f32 v64, v64, v67
    v_sub_f32 v64, 0, v64
    v_mov_b32 v65, v64
    v_mov_b32 v66, v64
    v_mov_b32 v67, v64
    v_max3_f32 v68, v68, v69, v70
    v_max_f32 v68, v68, v71
    v_sub_f32 v68, 0, v68
    v_mov_b32 v69, v68
    v_mov_b32 v70, v68
    v_mov_b32 v71, v68
    v_max3_f32 v72, v72, v73, v74
    v_max_f32 v72, v72, v75
    v_sub_f32 v72, 0, v72
    v_mov_b32 v73, v72
    v_mov_b32 v74, v72
    v_mov_b32 v75, v72
    v_max3_f32 v76, v76, v77, v78
    v_max_f32 v76, v76, v79
    v_sub_f32 v76, 0, v76
    v_mov_b32 v77, v76
    v_mov_b32 v78, v76
    v_mov_b32 v79, v76
    v_max3_f32 v80, v80, v81, v82
    v_max_f32 v80, v80, v83
    v_sub_f32 v80, 0, v80
    v_mov_b32 v81, v80
    v_mov_b32 v82, v80
    v_mov_b32 v83, v80
    s_branch L_noat
L_end:
.section .rodata,"a"
.p2align 6
.amdhsa_kernel standalone__gqa_block_cached__near_ridge_kernel
  .amdhsa_next_free_vgpr 512
  .amdhsa_next_free_sgpr 102
  .amdhsa_accum_offset 256
  .amdhsa_group_segment_fixed_size 0
  .amdhsa_kernarg_size 64
  .amdhsa_user_sgpr_count 2
  .amdhsa_user_sgpr_kernarg_segment_ptr 1
  .amdhsa_system_sgpr_workgroup_id_x 1
.end_amdhsa_kernel
```
